```python
import torch

def _softmax(x, axis=-1):
    return torch.softmax(x, dim=axis)
def _gelu(x):
    return torch.nn.functional.gelu(x, approximate="tanh")
def _silu(x):
    return torch.nn.functional.silu(x)
def _sigmoid(x):
    return torch.sigmoid(x)
def _layernorm(x, axis=-1, eps=1e-5):
    m = x.mean(dim=axis, keepdim=True)
    v = x.var(dim=axis, keepdim=True, unbiased=False)
    return (x - m) / torch.sqrt(v + eps)
def _scatter_add(tgt, idx, src, axis=0):
    return tgt.clone().index_add_(axis, idx, src)
def _segment_sum(src, seg, n):
    out = torch.zeros((n,) + src.shape[1:], dtype=src.dtype)
    return out.index_add_(0, seg, src)
def _pad(x, pw):
    flat = tuple(v for pair in reversed(pw) for v in pair)
    return torch.nn.functional.pad(x, flat)

kernel_name = 'concat_heads__ssm_conv_s4__spectral_gfnet__prompt'

def setup_inputs():

    _w = (lambda a: (lambda t: t.to(torch.bfloat16) if t.is_floating_point() else t)(torch.as_tensor(a)))
    def _A_setup():
        B, L, D, N = 1, 2048, 512, 128
        A_re = -(lambda _x: torch.exp(torch.as_tensor(_x)))((lambda *s: torch.randn(*s, dtype=torch.bfloat16) * 6.4)(D, N))
        A_im = torch.pi * (lambda *s: torch.randn(*s, dtype=torch.bfloat16) * 0.05)(D, N)
        B_re = (lambda *s: torch.randn(*s, dtype=torch.bfloat16) * 0.1)(D, N)
        B_im = (lambda *s: torch.randn(*s, dtype=torch.bfloat16) * 0.1)(D, N)
        C_re = (lambda *s: torch.randn(*s, dtype=torch.bfloat16) * 0.1)(D, N)
        C_im = (lambda *s: torch.randn(*s, dtype=torch.bfloat16) * 0.1)(D, N)
        log_dt = (lambda *s: torch.randn(*s, dtype=torch.bfloat16) * 0.05)(D) * 0.5 - 4.0
        Dskip = (lambda *s: torch.randn(*s, dtype=torch.bfloat16) * 0.05)(D)
        return {
            "u": _w((lambda *s: torch.randn(*s, dtype=torch.bfloat16) * 0.05)(B, L, D)),
            "A_re": _w(A_re),
            "A_im": _w(A_im),
            "B_re": _w(B_re),
            "B_im": _w(B_im),
            "C_re": _w(C_re),
            "C_im": _w(C_im),
            "log_dt": _w(log_dt),
            "Dskip": _w(Dskip),
        }
    _A_in = _A_setup()

    def _B_setup():
        B, S, D = 1, 2048, 512
        Df = D // 2 + 1
        return {
            "x": _w((lambda *s: torch.randn(*s, dtype=torch.bfloat16) * 0.05)(B, S, D)),
            "w_r": _w((lambda *s: torch.randn(*s, dtype=torch.bfloat16) * 1.6)(S, Df) * 0.02),
            "w_i": _w((lambda *s: torch.randn(*s, dtype=torch.bfloat16) * 1.6)(S, Df) * 0.02),
        }
    _B_in = _B_setup()

    return {
        "A_u": _A_in["u"],
        "A_A_re": _A_in["A_re"],
        "A_A_im": _A_in["A_im"],
        "A_B_re": _A_in["B_re"],
        "A_B_im": _A_in["B_im"],
        "A_C_re": _A_in["C_re"],
        "A_C_im": _A_in["C_im"],
        "A_log_dt": _A_in["log_dt"],
        "A_Dskip": _A_in["Dskip"],
        "B_x": _B_in["x"],
        "B_w_r": _B_in["w_r"],
        "B_w_i": _B_in["w_i"],
    }

def reference(A_u, A_A_re, A_A_im, A_B_re, A_B_im, A_C_re, A_C_im, A_log_dt, A_Dskip, B_x, B_w_r, B_w_i):
    def _A_ref(u, A_re, A_im, B_re, B_im, C_re, C_im, log_dt, Dskip):
        Bsz, L, D = u.shape
        dt = torch.exp(log_dt)[:, None]
        A = A_re + 1j * A_im
        Bc = B_re + 1j * B_im
        Cc = C_re + 1j * C_im
        logdA = dt * A
        dB = dt * Bc
        l = (lambda x, dt: x.to(dt))(torch.arange(L), A_re.dtype)
        P = torch.exp(logdA[:, :, None] * l[None, None, :])
        K = torch.einsum("dn,dnl,dn->dl", Cc, P, dB).real
        L2 = 2 * L
        Kp = _pad(K, ((0, 0), (0, L)))
        up = (lambda x, *d: x.permute(*d))(u, 0, 2, 1)
        up = _pad(up, ((0, 0), (0, 0), (0, L)))
        Kf = (lambda x, axes=(-2,-1): torch.fft.rfft2(x.float(), dim=axes))(Kp[:, None, :], axes=(-2, -1))
        Uf = (lambda x, axes=(-2,-1): torch.fft.rfft2(x.float(), dim=axes))(up[:, :, None, :], axes=(-2, -1))
        Yf = Uf * Kf[None, :, :, :]
        y = (lambda x, s, axes=(-2,-1): torch.fft.irfft2(x, s=s, dim=axes).to(torch.bfloat16))(Yf, (1, L2), axes=(-2, -1))[:, :, 0, :L]
        y = (lambda x, *d: x.permute(*d))(y, 0, 2, 1) + u * Dskip[None, None, :]
        return y

    def _B_ref(x, w_r, w_i):
        B, S, D = x.shape
        X = (lambda x, axes=(-2,-1): torch.fft.rfft2(x.float(), dim=axes))(x, axes=(-2, -1))
        W = w_r + 1j * w_i
        X = X * W
        y = (lambda x, s, axes=(-2,-1): torch.fft.irfft2(x, s=s, dim=axes).to(torch.bfloat16))(X, (S, D), axes=(-2, -1))
        return y

    a = _A_ref(A_u, A_A_re, A_A_im, A_B_re, A_B_im, A_C_re, A_C_im, A_log_dt, A_Dskip)
    b = _B_ref(B_x, B_w_r, B_w_i)
    return torch.concatenate([a, b], axis=-1)
```

```asm
; @launch grid=(256,1,1) block=(576,1,1) lds=121600
.amdgcn_target "amdgcn-amd-amdhsa--gfx950"
.text
.globl concat_heads__ssm_conv_s4__spectral_gfnet__prompt_kernel
.p2align 8
.type concat_heads__ssm_conv_s4__spectral_gfnet__prompt_kernel,@function
concat_heads__ssm_conv_s4__spectral_gfnet__prompt_kernel:
    s_load_dwordx16 s[4:19], s[0:1], 0
    s_load_dwordx8 s[20:27], s[0:1], 64
    s_load_dwordx4 s[28:31], s[0:1], 96
    s_load_dwordx2 s[32:33], s[0:1], 112
    s_cmp_ge_u32 s2, 256
    s_cbranch_scc1 L_end
    s_getpc_b64 s[92:93]
L_pc:
    s_mov_b32 s94, L_codeend-L_pc
    s_mov_b32 s95, 0x20000
    v_lshlrev_b32 v4, 7, v0
    buffer_load_dword v7, v4, s[92:95], 0 offen
    v_lshrrev_b32 v4, 6, v0
    v_and_b32 v1, 63, v0
    s_and_b32 s38, s2, 7
    v_readfirstlane_b32 s37, v4
    s_bfe_u32 s36, s2, 0x40003
    s_lshl_b32 s38, s38, 4
    s_add_u32 s36, s36, s38
    s_lshl_b32 s39, s36, 14
    s_lshl_b32 s40, s36, 10
    s_cmp_ge_u32 s2, 128
    s_cselect_b32 s39, s39, s40
    s_cselect_b32 s40, 1, 0x80
    s_lshl_b32 s40, s40, 10
    s_lshl3_add_u32 s44, s37, 8
    s_load_dwordx2 s[90:91], s[0:1], s44
    s_lshl_b32 s38, s37, 7
    s_add_u32 s39, s39, s38
    s_lshl_b32 s41, s37, 11
    v_lshrrev_b32 v4, 2, v1
    v_and_b32 v4, 4, v4
    v_and_b32 v5, 7, v1
    v_xor_b32 v4, v4, v5
    v_lshl_add_u32 v4, v4, 4, s39
    v_lshrrev_b32 v5, 3, v1
    v_mad_u32_u24 v4, v5, s40, v4
    s_lshl_b32 s40, s40, 3
    s_sub_u32 s40, s40, 1024
    v_xor_b32 v5, 32, v4
    v_add_u32 v5, s40, v5
    s_mov_b32 s34, 8388608
    s_mov_b32 s35, 0x20000
    v_and_b32 v2, 15, v1
    v_lshrrev_b32 v3, 4, v1
    s_lshl_b32 s38, s36, 10
    s_cmp_ge_u32 s37, 6
    s_cselect_b32 s38, 0, s38
    v_lshl_add_u32 v6, v1, 4, s38
    s_lshl_b32 s38, s37, 10
    s_add_u32 m0, s38, 113408
    s_cmp_eq_u32 s37, 8
    s_waitcnt lgkmcnt(0)
    s_cbranch_scc1 L_noload
    s_cmp_ge_u32 s2, 128
    s_cselect_b64 s[42:43], s[4:5], s[22:23]
    s_cbranch_scc0 L_nopar
    global_load_lds_dwordx4 v6, s[90:91]
L_nopar:
    s_mov_b32 m0, s41
    s_nop 0
    global_load_lds_dwordx4 v4, s[42:43]
    global_load_lds_dwordx4 v5, s[42:43] offset:1024
    s_branch L_loaded
L_noload:
    s_lshr_b32 s38, s2, 7
    s_lshl_b32 s38, s38, 7
    s_add_u32 s38, s38, 4456448
    buffer_load_dword v6, off, s[32:35], s38 sc1
L_loaded:
    s_cmp_ge_u32 s2, 128
    s_cbranch_scc1 L_conv
L_spec:
    v_cvt_f32_u32 v9, v2
    v_cvt_f32_u32 v10, v3
    v_lshlrev_b32 v8, 4, v1
    v_and_b32 v4, 1, v3
    v_lshrrev_b32 v5, 1, v3
    v_add_u32 v8, 76480, v8
    s_cmp_ge_u32 s37, 4
    s_cbranch_scc1 L_job_2
    s_cmp_ge_u32 s37, 2
    s_cbranch_scc1 L_job_3
    s_cmp_ge_u32 s37, 1
    s_cbranch_scc1 L_job_4
    v_lshrrev_b32 v11, 1, v2
    v_and_b32 v20, 1, v2
    v_cmp_eq_u32 vcc, 1, v2
    v_cvt_f32_u32 v12, v20
    s_nop 0
    v_cndmask_b32 v11, v11, 8, vcc
    v_mul_f32 v12, 0x3e800000, v12
    v_cvt_f32_u32 v20, v11
    v_cndmask_b32 v12, v12, 0, vcc
    v_mul_f32 v20, 0x3d800000, v20
    v_mul_f32 v11, v10, v20
    v_fma_f32 v11, v11, 4.0, v12
    v_cos_f32 v12, v11
    v_add_f32 v11, v11, v20
    v_cos_f32 v13, v11
    v_add_f32 v11, v11, v20
    v_cos_f32 v14, v11
    v_add_f32 v11, v11, v20
    v_cos_f32 v15, v11
    v_cvt_pk_bf16_f32 v24, v12, v13
    v_cvt_pk_bf16_f32 v25, v14, v15
    ds_write_b64 v8, v[24:25] offset:0
    v_mov_b32 v24, 0
    v_mov_b32 v25, 0
    v_mov_b32 v26, 0
    v_mov_b32 v27, 0
    v_lshlrev_b32 v22, 4, v1
    ds_write_b128 v22, v[24:27] offset:33536
    ds_write_b128 v22, v[24:27] offset:33584
    s_branch L_jobdone_1
L_job_4:
    v_mul_f32 v20, 0x3d000000, v9
    v_add_f32 v22, 0, v10
    v_mul_f32 v11, 4.0, v20
    v_mul_f32 v11, v11, v22
    v_cos_f32 v12, v11
    v_sin_f32 v16, v11
    v_add_f32 v11, v11, v20
    v_cos_f32 v13, v11
    v_sin_f32 v17, v11
    v_add_f32 v11, v11, v20
    v_cos_f32 v14, v11
    v_sin_f32 v18, v11
    v_add_f32 v11, v11, v20
    v_cos_f32 v15, v11
    v_sin_f32 v19, v11
    v_cvt_pk_bf16_f32 v24, v12, v13
    v_cvt_pk_bf16_f32 v25, v14, v15
    ds_write_b64 v8, v[24:25] offset:7168
    v_cvt_pk_bf16_f32 v26, v16, v17
    v_cvt_pk_bf16_f32 v27, v18, v19
    ds_write_b64 v8, v[26:27] offset:8192
    v_cvt_pk_bf16_f32 v28, -v16, -v17
    v_cvt_pk_bf16_f32 v29, -v18, -v19
    ds_write_b64 v8, v[28:29] offset:9216
    s_branch L_jobdone_1
L_job_3:
    s_cmp_ge_u32 s37, 3
    s_cbranch_scc1 L_job_5
    v_mul_f32 v20, 0x3d000000, v9
    v_add_f32 v22, 4.0, v10
    v_mul_f32 v11, 4.0, v20
    v_mul_f32 v11, v11, v22
    v_cos_f32 v12, v11
    v_sin_f32 v16, v11
    v_add_f32 v11, v11, v20
    v_cos_f32 v13, v11
    v_sin_f32 v17, v11
    v_add_f32 v11, v11, v20
    v_cos_f32 v14, v11
    v_sin_f32 v18, v11
    v_add_f32 v11, v11, v20
    v_cos_f32 v15, v11
    v_sin_f32 v19, v11
    v_cvt_pk_bf16_f32 v24, v12, v13
    v_cvt_pk_bf16_f32 v25, v14, v15
    ds_write_b64 v8, v[24:25] offset:7176
    v_cvt_pk_bf16_f32 v26, v16, v17
    v_cvt_pk_bf16_f32 v27, v18, v19
    ds_write_b64 v8, v[26:27] offset:8200
    v_cvt_pk_bf16_f32 v28, -v16, -v17
    v_cvt_pk_bf16_f32 v29, -v18, -v19
    ds_write_b64 v8, v[28:29] offset:9224
    s_branch L_jobdone_1
L_job_5:
    v_mul_f32 v20, 0x3d000000, v9
    v_add_f32 v22, 0, v10
    v_mul_f32 v11, 4.0, v20
    v_mul_f32 v11, v11, v22
    v_cos_f32 v12, v11
    v_sin_f32 v16, v11
    v_add_f32 v11, v11, v20
    v_cos_f32 v13, v11
    v_sin_f32 v17, v11
    v_add_f32 v11, v11, v20
    v_cos_f32 v14, v11
    v_sin_f32 v18, v11
    v_add_f32 v11, v11, v20
    v_cos_f32 v15, v11
    v_sin_f32 v19, v11
    v_cvt_pk_bf16_f32 v24, v12, -v13
    v_cvt_pk_bf16_f32 v25, v14, -v15
    ds_write_b64 v8, v[24:25] offset:10240
    v_cvt_pk_bf16_f32 v26, v16, -v17
    v_cvt_pk_bf16_f32 v27, v18, -v19
    ds_write_b64 v8, v[26:27] offset:11264
    v_cvt_pk_bf16_f32 v28, -v16, v17
    v_cvt_pk_bf16_f32 v29, -v18, v19
    ds_write_b64 v8, v[28:29] offset:12288
    s_branch L_jobdone_1
L_job_2:
    s_cmp_ge_u32 s37, 6
    s_cbranch_scc1 L_job_6
    s_cmp_ge_u32 s37, 5
    s_cbranch_scc1 L_job_7
    v_mul_f32 v20, 0x3b000000, v9
    v_add_f32 v22, 0, v10
    v_mul_f32 v11, 4.0, v20
    v_mul_f32 v11, v11, v22
    v_cos_f32 v12, v11
    v_sin_f32 v16, v11
    v_add_f32 v11, v11, v20
    v_cos_f32 v13, v11
    v_sin_f32 v17, v11
    v_add_f32 v11, v11, v20
    v_cos_f32 v14, v11
    v_sin_f32 v18, v11
    v_add_f32 v11, v11, v20
    v_cos_f32 v15, v11
    v_sin_f32 v19, v11
    ds_write_b128 v8, v[12:15] offset:3072
    ds_write_b128 v8, v[16:19] offset:5120
    s_branch L_jobdone_1
L_job_7:
    v_cvt_f32_u32 v22, v4
    v_cvt_f32_u32 v23, v5
    v_mul_f32 v20, 0x3d800000, v9
    v_fma_f32 v22, v22, 2.0, 0
    v_mul_f32 v23, 0x3e800000, v23
    v_mul_f32 v22, 4.0, v22
    v_fma_f32 v11, v22, v20, -v23
    v_cos_f32 v12, v11
    v_sin_f32 v16, v11
    v_add_f32 v11, v11, v20
    v_cos_f32 v13, v11
    v_sin_f32 v17, v11
    v_add_f32 v11, v11, v20
    v_cos_f32 v14, v11
    v_sin_f32 v18, v11
    v_add_f32 v11, v11, v20
    v_cos_f32 v15, v11
    v_sin_f32 v19, v11
    v_cvt_pk_bf16_f32 v24, v12, v13
    v_cvt_pk_bf16_f32 v26, -v16, -v17
    v_cvt_pk_bf16_f32 v25, v14, v15
    v_cvt_pk_bf16_f32 v27, -v18, -v19
    ds_write_b64 v8, v[24:25] offset:1024
    ds_write_b64 v8, v[26:27] offset:2048
    s_branch L_jobdone_1
L_job_6:
    s_cmp_ge_u32 s37, 7
    s_cbranch_scc1 L_job_8
    v_cvt_f32_u32 v22, v4
    v_cvt_f32_u32 v23, v5
    v_mul_f32 v20, 0x3d800000, v9
    v_fma_f32 v22, v22, 2.0, 1.0
    v_mul_f32 v23, 0x3e800000, v23
    v_mul_f32 v22, 4.0, v22
    v_fma_f32 v11, v22, v20, -v23
    v_cos_f32 v12, v11
    v_sin_f32 v16, v11
    v_add_f32 v11, v11, v20
    v_cos_f32 v13, v11
    v_sin_f32 v17, v11
    v_add_f32 v11, v11, v20
    v_cos_f32 v14, v11
    v_sin_f32 v18, v11
    v_add_f32 v11, v11, v20
    v_cos_f32 v15, v11
    v_sin_f32 v19, v11
    v_cvt_pk_bf16_f32 v24, v12, v13
    v_cvt_pk_bf16_f32 v26, -v16, -v17
    v_cvt_pk_bf16_f32 v25, v14, v15
    v_cvt_pk_bf16_f32 v27, -v18, -v19
    ds_write_b64 v8, v[24:25] offset:1032
    ds_write_b64 v8, v[26:27] offset:2056
    s_branch L_jobdone_1
L_job_8:
    s_cmp_ge_u32 s37, 8
    s_cbranch_scc1 L_job_9
    v_mul_f32 v20, 0x3d000000, v9
    v_add_f32 v22, 4.0, v10
    v_mul_f32 v11, 4.0, v20
    v_mul_f32 v11, v11, v22
    v_cos_f32 v12, v11
    v_sin_f32 v16, v11
    v_add_f32 v11, v11, v20
    v_cos_f32 v13, v11
    v_sin_f32 v17, v11
    v_add_f32 v11, v11, v20
    v_cos_f32 v14, v11
    v_sin_f32 v18, v11
    v_add_f32 v11, v11, v20
    v_cos_f32 v15, v11
    v_sin_f32 v19, v11
    v_cvt_pk_bf16_f32 v24, v12, -v13
    v_cvt_pk_bf16_f32 v25, v14, -v15
    ds_write_b64 v8, v[24:25] offset:10248
    v_cvt_pk_bf16_f32 v26, v16, -v17
    v_cvt_pk_bf16_f32 v27, v18, -v19
    ds_write_b64 v8, v[26:27] offset:11272
    v_cvt_pk_bf16_f32 v28, -v16, v17
    v_cvt_pk_bf16_f32 v29, -v18, v19
    ds_write_b64 v8, v[28:29] offset:12296
    s_branch L_jobdone_1
L_job_9:
    v_mul_f32 v20, 0x3b000000, v9
    v_add_f32 v22, 4.0, v10
    v_mul_f32 v11, 4.0, v20
    v_mul_f32 v11, v11, v22
    v_cos_f32 v12, v11
    v_sin_f32 v16, v11
    v_add_f32 v11, v11, v20
    v_cos_f32 v13, v11
    v_sin_f32 v17, v11
    v_add_f32 v11, v11, v20
    v_cos_f32 v14, v11
    v_sin_f32 v18, v11
    v_add_f32 v11, v11, v20
    v_cos_f32 v15, v11
    v_sin_f32 v19, v11
    ds_write_b128 v8, v[12:15] offset:4096
    ds_write_b128 v8, v[16:19] offset:6144
L_jobdone_1:
    s_waitcnt lgkmcnt(0)
    s_barrier
    ds_read_b64 v[12:13], v8 offset:0
    ds_read_b128 v[14:17], v8 offset:1024
    ds_read_b128 v[18:21], v8 offset:2048
    ds_read_b128 v[22:25], v8 offset:3072
    ds_read_b128 v[30:33], v8 offset:5120
    ds_read_b128 v[26:29], v8 offset:4096
    ds_read_b128 v[34:37], v8 offset:6144
    ds_read_b128 v[38:41], v8 offset:7168
    ds_read_b128 v[46:49], v8 offset:8192
    ds_read_b128 v[54:57], v8 offset:9216
    ds_read_b128 v[42:45], v8 offset:10240
    ds_read_b128 v[50:53], v8 offset:11264
    ds_read_b128 v[58:61], v8 offset:12288
    v_bfe_u32 v11, v1, 2, 2
    v_and_b32 v62, 3, v1
    v_lshl_add_u32 v69, v3, 2, v11
    v_lshlrev_b32 v63, 1, v11
    v_and_b32 v63, 4, v63
    v_lshl_add_u32 v63, v5, 1, v63
    v_xor_b32 v63, v63, v62
    v_lshlrev_b32 v63, 4, v63
    v_lshl_add_u32 v63, v69, 7, v63
    v_add_u32 v63, s41, v63
    v_xor_b32 v64, 64, v63
    s_lshl_b32 s38, s37, 7
    s_lshr_b32 s39, s37, 2
    s_lshl_b32 s39, s39, 5
    s_add_u32 s38, s38, s39
    v_mul_u32_u24 v65, 1072, v2
    v_lshl_add_u32 v65, v3, 4, v65
    v_add_u32 v65, s38, v65
    s_lshr_b32 s38, s36, 4
    s_and_b32 s62, s36, 7
    s_bfe_u32 s40, s36, 0x10003
    s_lshl_b32 s51, s40, 3
    s_cmp_eq_u32 s38, 0
    s_cselect_b32 s51, s51, s38
    s_cselect_b32 s40, 0, s40
    s_mul_i32 s52, s51, 514
    s_lshl_b32 s42, s62, 6
    s_add_u32 s52, s52, s42
    s_sub_u32 s43, 1053122, s52
    s_cmp_eq_u32 s40, 0
    s_cselect_b32 s52, s52, s43
    s_cselect_b32 s53, 1, -1
    s_mul_i32 s53, s53, 8224
    v_xor_b32 v69, v62, v3
    v_lshl_add_u32 v69, v69, 4, s52
    v_lshrrev_b32 v68, 2, v0
    v_mad_i32_i24 v68, v68, s53, v69
    s_lshl_b32 s63, s37, 10
    s_add_u32 s63, s63, 60096
    s_lshl_b32 s44, s37, 1
    s_add_u32 s45, s44, 1
    s_lshr_b32 s39, s37, 3
    s_lshl_b32 s40, s39, 10
    s_and_b32 s38, s37, 7
    s_cselect_b32 s44, s44, s39
    s_cselect_b32 s45, s45, 16
    s_cselect_b32 s46, s41, s40
    s_cselect_b32 s48, 0, 1
    s_cselect_b32 s47, 1, 1048576
    s_lshl_b32 s47, s47, 10
    s_mov_b32 s49, 0
    s_lshl_b32 s38, s36, 14
    s_add_u32 s46, s46, s38
    s_add_u32 s47, s47, s46
    s_mul_i32 s38, s44, 1072
    s_mul_i32 s39, s45, 1072
    s_sub_u32 s39, s39, s38
    v_mul_u32_u24 v66, 544, v4
    v_lshl_add_u32 v66, v11, 6, v66
    v_lshl_add_u32 v66, v62, 3, v66
    v_mad_u32_u24 v66, v5, s39, v66
    v_add_u32 v66, s38, v66
    v_lshlrev_b32 v67, 6, v2
    v_lshl_add_u32 v67, v3, 4, v67
    s_cmp_eq_u32 s37, 8
    s_cbranch_scc1 L_now_10
    s_mov_b32 m0, s63
    s_add_u32 s38, s63, 8192
    global_load_lds_dwordx4 v68, s[24:25]
    s_mov_b32 m0, s38
    s_nop 0
    global_load_lds_dwordx4 v68, s[26:27]
L_now_10:
    s_setprio 2
    s_cmp_eq_u32 s37, 8
    s_cbranch_scc1 L_bs1_11
    s_waitcnt vmcnt(2) lgkmcnt(0)
    ds_read_b64_tr_b16 v[70:71], v63 offset:0
    ds_read_b64_tr_b16 v[72:73], v63 offset:8
    ds_read_b64_tr_b16 v[74:75], v64 offset:0
    ds_read_b64_tr_b16 v[76:77], v64 offset:8
    s_waitcnt lgkmcnt(3)
    v_mfma_f32_16x16x16_bf16 v[78:81], v[70:71], v[12:13], 0
    s_waitcnt lgkmcnt(2)
    v_mfma_f32_16x16x16_bf16 v[82:85], v[72:73], v[12:13], 0
    s_waitcnt lgkmcnt(1)
    v_mfma_f32_16x16x16_bf16 v[86:89], v[74:75], v[12:13], 0
    s_waitcnt lgkmcnt(0)
    v_mfma_f32_16x16x16_bf16 v[90:93], v[76:77], v[12:13], 0
    s_nop 1
    v_cvt_pk_bf16_f32 v94, v78, v79
    v_cvt_pk_bf16_f32 v95, v80, v81
    v_cvt_pk_bf16_f32 v96, v82, v83
    v_cvt_pk_bf16_f32 v97, v84, v85
    ds_write_b128 v65, v[94:97] offset:16384
    v_cvt_pk_bf16_f32 v98, v86, v87
    v_cvt_pk_bf16_f32 v99, v88, v89
    v_cvt_pk_bf16_f32 v100, v90, v91
    v_cvt_pk_bf16_f32 v101, v92, v93
    ds_write_b128 v65, v[98:101] offset:16448
    s_branch L_bs1w_12
L_bs1_11:
    s_waitcnt vmcnt(0)
    s_lshl_b32 s38, s36, 10
    s_add_u32 s38, s38, 4194304
    v_lshlrev_b32 v69, 4, v1
    v_mov_b32 v102, v6
    v_mov_b32 v103, v6
    v_mov_b32 v104, v6
    v_mov_b32 v105, v6
    buffer_store_dwordx4 v[102:105], v69, s[32:35], s38 offen sc1
L_bs1w_12:
    s_waitcnt lgkmcnt(0)
    s_barrier
    ds_read_b64_tr_b16 v[70:71], v66 offset:16384
    ds_read_b64_tr_b16 v[72:73], v66 offset:16640
    ds_read_b64_tr_b16 v[74:75], v66 offset:16416
    ds_read_b64_tr_b16 v[76:77], v66 offset:16672
    s_waitcnt lgkmcnt(2)
    v_mfma_f32_16x16x32_bf16 v[78:81], v[70:73], v[14:17], 0
    v_mfma_f32_16x16x32_bf16 v[82:85], v[70:73], v[18:21], 0
    s_waitcnt lgkmcnt(0)
    v_mfma_f32_16x16x32_bf16 v[86:89], v[74:77], v[14:17], 0
    v_mfma_f32_16x16x32_bf16 v[90:93], v[74:77], v[18:21], 0
    s_nop 3
    v_pk_mul_f32 v[102:103], v[78:79], v[22:23]
    v_pk_mul_f32 v[104:105], v[82:83], v[22:23]
    v_pk_fma_f32 v[102:103], v[82:83], v[30:31], v[102:103]
    v_pk_fma_f32 v[104:105], v[78:79], v[30:31], v[104:105] neg_lo:[1,0,0] neg_hi:[1,0,0]
    v_cvt_pk_bf16_f32 v94, v102, v103
    v_cvt_pk_bf16_f32 v98, v104, v105
    v_pk_mul_f32 v[102:103], v[80:81], v[24:25]
    v_pk_mul_f32 v[104:105], v[84:85], v[24:25]
    v_pk_fma_f32 v[102:103], v[84:85], v[32:33], v[102:103]
    v_pk_fma_f32 v[104:105], v[80:81], v[32:33], v[104:105] neg_lo:[1,0,0] neg_hi:[1,0,0]
    v_cvt_pk_bf16_f32 v95, v102, v103
    v_cvt_pk_bf16_f32 v99, v104, v105
    v_pk_mul_f32 v[102:103], v[86:87], v[26:27]
    v_pk_mul_f32 v[104:105], v[90:91], v[26:27]
    v_pk_fma_f32 v[102:103], v[90:91], v[34:35], v[102:103]
    v_pk_fma_f32 v[104:105], v[86:87], v[34:35], v[104:105] neg_lo:[1,0,0] neg_hi:[1,0,0]
    v_cvt_pk_bf16_f32 v96, v102, v103
    v_cvt_pk_bf16_f32 v100, v104, v105
    v_pk_mul_f32 v[102:103], v[88:89], v[28:29]
    v_pk_mul_f32 v[104:105], v[92:93], v[28:29]
    v_pk_fma_f32 v[102:103], v[92:93], v[36:37], v[102:103]
    v_pk_fma_f32 v[104:105], v[88:89], v[36:37], v[104:105] neg_lo:[1,0,0] neg_hi:[1,0,0]
    v_cvt_pk_bf16_f32 v97, v102, v103
    v_cvt_pk_bf16_f32 v101, v104, v105
    s_nop 0
    v_mfma_f32_16x16x32_bf16 v[114:117], v[94:97], v[42:45], 0
    v_mfma_f32_16x16x32_bf16 v[118:121], v[94:97], v[58:61], 0
    v_mfma_f32_16x16x32_bf16 v[114:117], v[98:101], v[50:53], v[114:117]
    v_mfma_f32_16x16x32_bf16 v[118:121], v[98:101], v[42:45], v[118:121]
    v_mfma_f32_16x16x32_bf16 v[106:109], v[94:97], v[38:41], 0
    v_mfma_f32_16x16x32_bf16 v[110:113], v[94:97], v[54:57], 0
    v_mfma_f32_16x16x32_bf16 v[106:109], v[98:101], v[46:49], v[106:109]
    v_mfma_f32_16x16x32_bf16 v[110:113], v[98:101], v[38:41], v[110:113]
    s_nop 2
    v_cvt_pk_bf16_f32 v74, v114, v115
    v_cvt_pk_bf16_f32 v75, v116, v117
    v_cvt_pk_bf16_f32 v76, v118, v119
    v_cvt_pk_bf16_f32 v77, v120, v121
    buffer_store_dwordx4 v[74:77], v67, s[32:35], s47 offen sc1
    v_cndmask_b32 v110, v110, v114, s[48:49]
    v_cvt_pk_bf16_f32 v70, v106, v107
    v_cvt_pk_bf16_f32 v71, v108, v109
    v_cvt_pk_bf16_f32 v72, v110, v111
    v_cvt_pk_bf16_f32 v73, v112, v113
    buffer_store_dwordx4 v[70:73], v67, s[32:35], s46 offen sc1
    s_setprio 0
    v_mov_b32 v69, v70
    v_or_b32 v122, s48, v74
    s_cmp_ge_u32 s37, 4
    s_cbranch_scc1 L_job_14
    s_cmp_ge_u32 s37, 2
    s_cbranch_scc1 L_job_15
    s_cmp_ge_u32 s37, 1
    s_cbranch_scc1 L_job_16
    v_mul_f32 v21, 0x3b000000, v9
    v_mul_f32 v20, v10, v21
    v_mul_f32 v20, 4.0, v20
    v_cos_f32 v12, v20
    v_sin_f32 v16, v20
    v_add_f32 v20, v20, v21
    v_cos_f32 v13, v20
    v_sin_f32 v17, v20
    v_add_f32 v20, v20, v21
    v_cos_f32 v14, v20
    v_sin_f32 v18, v20
    v_add_f32 v20, v20, v21
    v_cos_f32 v15, v20
    v_sin_f32 v19, v20
    ds_write_b128 v8, v[12:15] offset:22528
    ds_write_b128 v8, v[16:19] offset:24576
    s_branch L_jobdone_13
L_job_16:
    v_cvt_f32_u32 v20, s51
    v_fmamk_f32 v22, v9, 0x41800000, v20
    v_cvt_f32_u32 v23, v4
    v_cvt_f32_u32 v24, v5
    v_mul_f32 v21, 0x3b800000, v22
    v_fma_f32 v23, v23, 2.0, 0
    v_mul_f32 v24, 0x3e800000, v24
    v_mul_f32 v23, 4.0, v23
    v_fma_f32 v20, v23, v21, -v24
    v_cos_f32 v12, v20
    v_sin_f32 v16, v20
    v_add_f32 v20, v20, v21
    v_cos_f32 v13, v20
    v_sin_f32 v17, v20
    v_add_f32 v20, v20, v21
    v_cos_f32 v14, v20
    v_sin_f32 v18, v20
    v_add_f32 v20, v20, v21
    v_cos_f32 v15, v20
    v_sin_f32 v19, v20
    v_cvt_pk_bf16_f32 v26, v12, v13
    v_cvt_pk_bf16_f32 v28, -v16, -v17
    v_cvt_pk_bf16_f32 v27, v14, v15
    v_cvt_pk_bf16_f32 v29, -v18, -v19
    ds_write_b64 v8, v[26:27] offset:13312
    ds_write_b64 v8, v[28:29] offset:14336
    s_branch L_jobdone_13
L_job_15:
    s_cmp_ge_u32 s37, 3
    s_cbranch_scc1 L_job_17
    v_cvt_f32_u32 v20, s51
    v_fmamk_f32 v22, v9, 0x41800000, v20
    v_cvt_f32_u32 v23, v4
    v_cvt_f32_u32 v24, v5
    v_mul_f32 v21, 0x3b800000, v22
    v_fma_f32 v23, v23, 2.0, 1.0
    v_mul_f32 v24, 0x3e800000, v24
    v_mul_f32 v23, 4.0, v23
    v_fma_f32 v20, v23, v21, -v24
    v_cos_f32 v12, v20
    v_sin_f32 v16, v20
    v_add_f32 v20, v20, v21
    v_cos_f32 v13, v20
    v_sin_f32 v17, v20
    v_add_f32 v20, v20, v21
    v_cos_f32 v14, v20
    v_sin_f32 v18, v20
    v_add_f32 v20, v20, v21
    v_cos_f32 v15, v20
    v_sin_f32 v19, v20
    v_cvt_pk_bf16_f32 v26, v12, v13
    v_cvt_pk_bf16_f32 v28, -v16, -v17
    v_cvt_pk_bf16_f32 v27, v14, v15
    v_cvt_pk_bf16_f32 v29, -v18, -v19
    ds_write_b64 v8, v[26:27] offset:13320
    ds_write_b64 v8, v[28:29] offset:14344
    s_branch L_jobdone_13
L_job_17:
    v_cvt_f32_u32 v20, s51
    v_fmamk_f32 v22, v9, 0x41800000, v20
    v_mul_f32 v21, 0x3a000000, v22
    v_mul_f32 v20, v10, v21
    v_mul_f32 v21, 4.0, v21
    v_cos_f32 v26, v20
    v_sin_f32 v28, v20
    v_add_f32 v20, v20, v21
    v_cos_f32 v27, v20
    v_sin_f32 v29, v20
    v_lshrrev_b32 v23, 1, v2
    v_and_b32 v24, 1, v2
    v_cvt_f32_u32 v23, v23
    v_cvt_f32_u32 v20, v24
    v_mul_f32 v26, 0x36000000, v26
    v_mul_f32 v27, 0x36000000, v27
    v_mul_f32 v28, 0x36000000, v28
    v_mul_f32 v29, 0x36000000, v29
    ds_write_b128 v8, v[26:29] offset:15360
    v_mul_f32 v21, 0x3e000000, v23
    v_mul_f32 v20, 0x3e800000, v20
    v_fmac_f32 v20, v10, v21
    v_mul_f32 v22, 4.0, v21
    v_cos_f32 v12, v20
    v_sin_f32 v16, v20
    v_add_f32 v20, v20, v22
    v_cos_f32 v13, v20
    v_sin_f32 v17, v20
    v_cvt_pk_bf16_f32 v30, v12, v16
    v_cvt_pk_bf16_f32 v31, v13, v17
    ds_write_b64 v8, v[30:31] offset:16384
    s_branch L_jobdone_13
L_job_14:
    s_cmp_ge_u32 s37, 6
    s_cbranch_scc1 L_job_18
    s_cmp_ge_u32 s37, 5
    s_cbranch_scc1 L_job_19
    v_cvt_f32_u32 v20, s51
    v_fmamk_f32 v24, v10, 0x42800000, v20
    v_lshrrev_b32 v23, 1, v2
    v_cvt_f32_u32 v23, v23
    v_mul_f32 v21, 0x3a000000, v23
    v_mul_f32 v20, v24, v21
    v_mul_f32 v21, 0x41800000, v21
    v_cos_f32 v12, v20
    v_sin_f32 v16, v20
    v_add_f32 v20, v20, v21
    v_cos_f32 v13, v20
    v_sin_f32 v17, v20
    v_add_f32 v20, v20, v21
    v_cos_f32 v14, v20
    v_sin_f32 v18, v20
    v_add_f32 v20, v20, v21
    v_cos_f32 v15, v20
    v_sin_f32 v19, v20
    ds_write_b128 v8, v[12:15] offset:20480
    ds_write_b128 v8, v[16:19] offset:21504
    s_branch L_jobdone_13
L_job_19:
    v_lshrrev_b32 v23, 1, v2
    v_and_b32 v24, 1, v2
    v_cvt_f32_u32 v23, v23
    v_mul_f32 v21, 0x3e000000, v23
    v_mul_f32 v20, v10, v21
    v_add_f32 v20, v20, v20
    v_cos_f32 v12, v20
    v_sin_f32 v16, v20
    v_add_f32 v20, v20, v21
    v_cos_f32 v13, v20
    v_sin_f32 v17, v20
    v_add_u32 v23, -1, v24
    v_not_b32 v24, v23
    v_cvt_pk_bf16_f32 v14, v12, -v16
    v_cvt_pk_bf16_f32 v18, v16, v12
    v_cvt_pk_bf16_f32 v15, v13, -v17
    v_cvt_pk_bf16_f32 v19, v17, v13
    v_and_b32 v26, v23, v14
    v_and_b32 v28, v24, v14
    v_and_b32 v30, v23, v18
    v_and_b32 v32, v24, v18
    v_and_b32 v27, v23, v15
    v_and_b32 v29, v24, v15
    v_and_b32 v31, v23, v19
    v_and_b32 v33, v24, v19
    ds_write_b128 v8, v[26:29] offset:18432
    ds_write_b128 v8, v[30:33] offset:19456
    s_branch L_jobdone_13
L_job_18:
    s_cmp_ge_u32 s37, 7
    s_cbranch_scc1 L_job_20
    v_cvt_f32_u32 v20, s51
    v_fmamk_f32 v24, v10, 0x42800000, v20
    v_mul_f32 v21, 0x3b800000, v9
    v_mul_f32 v20, v24, v21
    v_mul_f32 v21, 0x41800000, v21
    v_cos_f32 v12, v20
    v_sin_f32 v16, v20
    v_add_f32 v20, v20, v21
    v_cos_f32 v13, v20
    v_sin_f32 v17, v20
    v_add_f32 v20, v20, v21
    v_cos_f32 v14, v20
    v_sin_f32 v18, v20
    v_add_f32 v20, v20, v21
    v_cos_f32 v15, v20
    v_sin_f32 v19, v20
    v_cvt_pk_bf16_f32 v26, v16, v17
    v_cvt_pk_bf16_f32 v28, v12, v13
    v_cvt_pk_bf16_f32 v30, -v16, -v17
    v_cvt_pk_bf16_f32 v27, v18, v19
    v_cvt_pk_bf16_f32 v29, v14, v15
    v_cvt_pk_bf16_f32 v31, -v18, -v19
    ds_write_b128 v8, v[26:29] offset:17408
    ds_write_b64 v8, v[30:31] offset:16392
    s_branch L_jobdone_13
L_job_20:
    s_cmp_ge_u32 s37, 8
    s_cbranch_scc1 L_job_21
    v_mul_f32 v21, 0x3d800000, v9
    v_mul_f32 v23, v10, v21
    v_mul_f32 v20, 4.0, v23
    v_cos_f32 v12, v20
    v_sin_f32 v16, v20
    v_add_f32 v20, v20, v21
    v_cos_f32 v13, v20
    v_sin_f32 v17, v20
    v_add_f32 v20, v20, v21
    v_cos_f32 v14, v20
    v_sin_f32 v18, v20
    v_add_f32 v20, v20, v21
    v_cos_f32 v15, v20
    v_sin_f32 v19, v20
    v_cvt_pk_bf16_f32 v26, v16, v17
    v_cvt_pk_bf16_f32 v28, v12, v13
    v_cvt_pk_bf16_f32 v30, -v16, -v17
    v_cvt_pk_bf16_f32 v27, v18, v19
    v_cvt_pk_bf16_f32 v29, v14, v15
    v_cvt_pk_bf16_f32 v31, -v18, -v19
    ds_write_b128 v8, v[26:29] offset:26624
    ds_write_b64 v8, v[30:31] offset:27648
    v_add_f32 v20, v23, v23
    v_add_f32 v22, v20, v21
    v_cos_f32 v12, v20
    v_sin_f32 v13, v20
    v_cos_f32 v14, v22
    v_sin_f32 v15, v22
    v_mul_f32 v20, 0.5, v9
    v_cos_f32 v16, v20
    v_cmp_eq_u32 vcc, 0, v3
    s_nop 1
    v_cndmask_b32 v13, v13, -v16, vcc
    v_cvt_pk_bf16_f32 v32, v12, -v13
    v_cvt_pk_bf16_f32 v33, v14, -v15
    ds_write_b64 v8, v[32:33] offset:8
    s_branch L_jobdone_13
L_job_21:
    v_mul_f32 v21, 0x3b000000, v9
    v_add_f32 v21, 0x3d000000, v21
    v_mul_f32 v20, v10, v21
    v_mul_f32 v20, 4.0, v20
    v_cos_f32 v12, v20
    v_sin_f32 v16, v20
    v_add_f32 v20, v20, v21
    v_cos_f32 v13, v20
    v_sin_f32 v17, v20
    v_add_f32 v20, v20, v21
    v_cos_f32 v14, v20
    v_sin_f32 v18, v20
    v_add_f32 v20, v20, v21
    v_cos_f32 v15, v20
    v_sin_f32 v19, v20
    ds_write_b128 v8, v[12:15] offset:23552
    ds_write_b128 v8, v[16:19] offset:25600
L_jobdone_13:
    s_cmp_gt_i32 s53, 0
    s_cselect_b32 s54, 1.0, -1.0
    s_cselect_b32 s42, 0, 0x06060000
    s_cselect_b32 s55, 0, 7
    s_cmp_eq_u32 s37, 8
    s_cbranch_scc1 L_bhelp_22
    s_xor_b32 s55, s55, s37
    s_xor_b32 s56, s42, 0x01000c0c
    s_xor_b32 s57, s42, 0x03020c0c
    s_xor_b32 s58, s42, 0x05040c0c
    s_xor_b32 s59, s42, 0x07060c0c
    s_or_b32 s62, s62, s37
    s_lshl_b32 s60, s36, 7
    s_add_u32 s61, s60, 0x100000
    v_lshrrev_b32 v16, 3, v0
    v_and_b32 v17, 7, v0
    v_lshlrev_b32 v9, 14, v16
    v_lshl_add_u32 v9, v17, 4, v9
    v_mul_u32_u24 v10, 144, v16
    v_lshl_add_u32 v10, v17, 4, v10
    v_xor_b32 v17, s37, v17
    v_lshlrev_b32 v15, 7, v16
    v_lshl_add_u32 v15, v17, 4, v15
    v_lshrrev_b32 v16, 4, v16
    v_lshl_add_u32 v10, v16, 6, v10
    v_mul_u32_u24 v12, 9472, v4
    v_mul_u32_u24 v16, 1152, v11
    v_mul_u32_u24 v17, 144, v62
    v_add3_u32 v12, v12, v16, v17
    v_lshrrev_b32 v16, 1, v11
    v_lshl_add_u32 v12, v16, 6, v12
    v_lshl_add_u32 v12, v5, 3, v12
    s_lshl_b32 s38, s37, 4
    v_add_u32 v12, s38, v12
    s_lshr_b32 s38, s55, 1
    s_and_b32 s39, s55, 1
    s_lshl_b32 s39, s39, 3
    s_add_u32 s39, s39, 60096
    v_lshrrev_b32 v16, 2, v2
    v_xor_b32 v16, s38, v16
    v_lshl_add_u32 v13, v3, 5, v2
    v_lshl_add_u32 v13, v13, 6, s39
    v_lshl_add_u32 v13, v16, 4, v13
    v_and_b32 v16, 7, v2
    v_xor_b32 v16, s37, v16
    v_lshlrev_b32 v14, 10, v2
    v_lshl_add_u32 v14, v3, 8, v14
    v_lshl_add_u32 v14, v16, 4, v14
    s_waitcnt vmcnt(0) lgkmcnt(0)
    s_barrier
    ds_read_b32 v6, v8 offset:27656
    ds_read_b128 v[16:19], v8 offset:13312
    ds_read_b128 v[20:23], v8 offset:14336
    ds_read_b128 v[24:27], v8 offset:15360
    ds_read_b64 v[28:29], v8 offset:16384
    ds_read_b64 v[50:51], v8 offset:16392
    ds_read_b128 v[46:49], v8 offset:17408
    ds_read_b128 v[30:33], v8 offset:18432
    ds_read_b128 v[34:37], v8 offset:19456
    ds_read_b128 v[38:41], v8 offset:20480
    ds_read_b128 v[42:45], v8 offset:21504
    ds_read_b64 v[52:53], v13 offset:0
    ds_read_b64 v[54:55], v13 offset:1024
    ds_read_b64 v[56:57], v13 offset:8192
    ds_read_b64 v[58:59], v13 offset:9216
    s_waitcnt lgkmcnt(0)
    v_perm_b32 v70, v53, v52, s56
    v_perm_b32 v71, v57, v56, s56
    v_mul_f32 v71, s54, v71
    v_perm_b32 v72, v55, v54, s56
    v_perm_b32 v73, v59, v58, s56
    v_mul_f32 v73, s54, v73
    v_perm_b32 v74, v53, v52, s57
    v_perm_b32 v75, v57, v56, s57
    v_mul_f32 v75, s54, v75
    v_perm_b32 v76, v55, v54, s57
    v_perm_b32 v77, v59, v58, s57
    v_mul_f32 v77, s54, v77
    v_perm_b32 v78, v53, v52, s58
    v_perm_b32 v79, v57, v56, s58
    v_mul_f32 v79, s54, v79
    v_perm_b32 v80, v55, v54, s58
    v_perm_b32 v81, v59, v58, s58
    v_mul_f32 v81, s54, v81
    v_perm_b32 v82, v53, v52, s59
    v_perm_b32 v83, v57, v56, s59
    v_mul_f32 v83, s54, v83
    v_perm_b32 v84, v55, v54, s59
    v_perm_b32 v85, v59, v58, s59
    v_mul_f32 v85, s54, v85
    v_and_b32 v60, 7, v2
    v_lshrrev_b32 v61, 3, v2
    v_lshlrev_b32 v60, 10, v60
    v_lshl_add_u32 v60, v61, 16, v60
    s_lshl_b32 s39, s37, 13
    s_lshr_b32 s38, s36, 4
    s_lshl_b32 s38, s38, 7
    s_add_u32 s39, s39, s38
    s_add_u32 s39, s39, 4194304
    s_mov_b32 s38, 0
    s_mov_b64 exec, 0xffff
    s_sleep 4
L_fpoll_24:
    buffer_load_dword v61, v60, s[32:35], s39 offen sc1
    s_add_u32 s38, s38, 1
    s_waitcnt vmcnt(0)
    v_cmp_ne_u32 vcc, v61, v6
    s_nop 0
    s_cbranch_vccz L_fpolled_25
    s_mov_b64 exec, vcc
    s_cmp_lt_u32 s38, 400000
    s_cbranch_scc1 L_fpoll_24
L_fpolled_25:
    s_mov_b64 exec, -1
    s_setprio 2
    buffer_load_dwordx4 v[94:97], v9, s[32:35], s60 offen sc1
    buffer_load_dwordx4 v[98:101], v9, s[32:35], s61 offen sc1
    s_waitcnt vmcnt(1)
    ds_write_b128 v10, v[94:97] offset:0
    v_not_b32 v60, v94
    s_waitcnt vmcnt(0)
    ds_write_b128 v10, v[98:101] offset:9472
    v_not_b32 v61, v98
    s_waitcnt lgkmcnt(0)
    s_barrier
    ds_read_b64_tr_b16 v[94:95], v12 offset:0
    ds_read_b64_tr_b16 v[96:97], v12 offset:4736
    ds_read_b64_tr_b16 v[98:99], v12 offset:576
    ds_read_b64_tr_b16 v[100:101], v12 offset:5312
    s_cmp_lg_u32 s62, 0
    s_cbranch_scc1 L_nospec_26
    ds_read_b128 v[70:73], v8 offset:28672
    ds_read_b128 v[86:89], v8 offset:29696
    ds_read_b128 v[90:93], v8 offset:30720
    s_waitcnt lgkmcnt(0)
L_nospec_26:
    s_waitcnt lgkmcnt(2)
    v_mfma_f32_16x16x32_bf16 v[102:105], v[94:97], v[16:19], 0
    v_mfma_f32_16x16x32_bf16 v[106:109], v[94:97], v[20:23], 0
    s_waitcnt lgkmcnt(0)
    v_mfma_f32_16x16x32_bf16 v[110:113], v[98:101], v[16:19], 0
    v_mfma_f32_16x16x32_bf16 v[114:117], v[98:101], v[20:23], 0
    s_nop 3
    v_pk_mul_f32 v[118:119], v[102:103], v[24:25] op_sel:[0,0] op_sel_hi:[1,0]
    v_pk_mul_f32 v[120:121], v[106:107], v[24:25] op_sel:[0,0] op_sel_hi:[1,0]
    v_pk_fma_f32 v[118:119], v[106:107], v[26:27], v[118:119] op_sel:[0,0,0] op_sel_hi:[1,0,1]
    v_pk_fma_f32 v[120:121], v[102:103], v[26:27], v[120:121] op_sel:[0,0,0] op_sel_hi:[1,0,1] neg_lo:[1,0,0] neg_hi:[1,0,0]
    v_cvt_pk_bf16_f32 v140, v118, v120
    v_cvt_pk_bf16_f32 v142, v119, v121
    v_pk_mul_f32 v[118:119], v[110:111], v[24:25] op_sel:[0,1] op_sel_hi:[1,1]
    v_pk_mul_f32 v[120:121], v[114:115], v[24:25] op_sel:[0,1] op_sel_hi:[1,1]
    v_pk_fma_f32 v[118:119], v[114:115], v[26:27], v[118:119] op_sel:[0,1,0] op_sel_hi:[1,1,1]
    v_pk_fma_f32 v[120:121], v[110:111], v[26:27], v[120:121] op_sel:[0,1,0] op_sel_hi:[1,1,1] neg_lo:[1,0,0] neg_hi:[1,0,0]
    v_cvt_pk_bf16_f32 v141, v118, v120
    v_cvt_pk_bf16_f32 v143, v119, v121
    s_nop 0
    v_mfma_f32_16x16x16_bf16 v[124:127], v[28:29], v[140:141], 0
    v_pk_mul_f32 v[118:119], v[104:105], v[24:25] op_sel:[0,0] op_sel_hi:[1,0]
    v_pk_mul_f32 v[120:121], v[108:109], v[24:25] op_sel:[0,0] op_sel_hi:[1,0]
    v_pk_fma_f32 v[118:119], v[108:109], v[26:27], v[118:119] op_sel:[0,0,0] op_sel_hi:[1,0,1]
    v_pk_fma_f32 v[120:121], v[104:105], v[26:27], v[120:121] op_sel:[0,0,0] op_sel_hi:[1,0,1] neg_lo:[1,0,0] neg_hi:[1,0,0]
    v_cvt_pk_bf16_f32 v144, v118, v120
    v_cvt_pk_bf16_f32 v146, v119, v121
    v_mfma_f32_16x16x16_bf16 v[128:131], v[28:29], v[142:143], 0
    v_pk_mul_f32 v[118:119], v[112:113], v[24:25] op_sel:[0,1] op_sel_hi:[1,1]
    v_pk_mul_f32 v[120:121], v[116:117], v[24:25] op_sel:[0,1] op_sel_hi:[1,1]
    v_pk_fma_f32 v[118:119], v[116:117], v[26:27], v[118:119] op_sel:[0,1,0] op_sel_hi:[1,1,1]
    v_pk_fma_f32 v[120:121], v[112:113], v[26:27], v[120:121] op_sel:[0,1,0] op_sel_hi:[1,1,1] neg_lo:[1,0,0] neg_hi:[1,0,0]
    v_cvt_pk_bf16_f32 v145, v118, v120
    v_cvt_pk_bf16_f32 v147, v119, v121
    s_nop 0
    v_mfma_f32_16x16x16_bf16 v[132:135], v[28:29], v[144:145], 0
    v_mfma_f32_16x16x16_bf16 v[136:139], v[28:29], v[146:147], 0
    s_cmp_lg_u32 s62, 0
    s_cbranch_scc1 L_nospec_27
    ds_bpermute_b32 v52, v90, v124
    ds_bpermute_b32 v53, v90, v125
    ds_bpermute_b32 v54, v90, v126
    ds_bpermute_b32 v55, v90, v127
    ds_bpermute_b32 v56, v91, v124
    ds_bpermute_b32 v57, v91, v125
    ds_bpermute_b32 v58, v91, v126
    ds_bpermute_b32 v59, v91, v127
L_nospec_27:
    v_pk_mul_f32 v[118:119], v[128:129], v[74:75] op_sel:[1,1] op_sel_hi:[0,1]
    v_pk_fma_f32 v[118:119], v[128:129], v[74:75], v[118:119] op_sel_hi:[1,0,1] neg_lo:[0,0,1]
    v_pk_mul_f32 v[120:121], v[130:131], v[76:77] op_sel:[1,1] op_sel_hi:[0,1]
    v_pk_fma_f32 v[120:121], v[130:131], v[76:77], v[120:121] op_sel_hi:[1,0,1] neg_lo:[0,0,1]
    v_cvt_pk_bf16_f32 v96, v118, v119
    v_cvt_pk_bf16_f32 v97, v120, v121
    v_pk_mul_f32 v[118:119], v[132:133], v[78:79] op_sel:[1,1] op_sel_hi:[0,1]
    v_pk_fma_f32 v[118:119], v[132:133], v[78:79], v[118:119] op_sel_hi:[1,0,1] neg_lo:[0,0,1]
    v_pk_mul_f32 v[120:121], v[134:135], v[80:81] op_sel:[1,1] op_sel_hi:[0,1]
    v_pk_fma_f32 v[120:121], v[134:135], v[80:81], v[120:121] op_sel_hi:[1,0,1] neg_lo:[0,0,1]
    v_cvt_pk_bf16_f32 v98, v118, v119
    v_cvt_pk_bf16_f32 v99, v120, v121
    v_pk_mul_f32 v[118:119], v[136:137], v[82:83] op_sel:[1,1] op_sel_hi:[0,1]
    v_pk_fma_f32 v[118:119], v[136:137], v[82:83], v[118:119] op_sel_hi:[1,0,1] neg_lo:[0,0,1]
    v_pk_mul_f32 v[120:121], v[138:139], v[84:85] op_sel:[1,1] op_sel_hi:[0,1]
    v_pk_fma_f32 v[120:121], v[138:139], v[84:85], v[120:121] op_sel_hi:[1,0,1] neg_lo:[0,0,1]
    v_cvt_pk_bf16_f32 v100, v118, v119
    v_cvt_pk_bf16_f32 v101, v120, v121
    s_nop 1
    v_mfma_f32_16x16x32_bf16 v[110:113], v[98:101], v[30:33], 0
    v_mfma_f32_16x16x32_bf16 v[114:117], v[98:101], v[34:37], 0
    v_pk_mul_f32 v[118:119], v[124:125], v[70:71] op_sel:[1,1] op_sel_hi:[0,1]
    v_pk_fma_f32 v[118:119], v[124:125], v[70:71], v[118:119] op_sel_hi:[1,0,1] neg_lo:[0,0,1]
    v_pk_mul_f32 v[120:121], v[126:127], v[72:73] op_sel:[1,1] op_sel_hi:[0,1]
    v_pk_fma_f32 v[120:121], v[126:127], v[72:73], v[120:121] op_sel_hi:[1,0,1] neg_lo:[0,0,1]
    s_cmp_lg_u32 s62, 0
    s_cbranch_scc1 L_nospec_28
    s_waitcnt lgkmcnt(0)
    v_cmp_eq_u32 vcc, 1, v92
    s_nop 1
    v_cndmask_b32 v52, v52, v54, vcc
    v_cndmask_b32 v53, v53, v55, vcc
    v_fmac_f32 v118, v52, v86
    v_fmac_f32 v119, v52, v87
    v_fmac_f32 v118, v53, v87
    v_fma_f32 v119, -v53, v86, v119
    v_cmp_eq_u32 vcc, 1, v93
    s_nop 1
    v_cndmask_b32 v56, v56, v58, vcc
    v_cndmask_b32 v57, v57, v59, vcc
    v_fmac_f32 v120, v56, v88
    v_fmac_f32 v121, v56, v89
    v_fmac_f32 v120, v57, v89
    v_fma_f32 v121, -v57, v88, v121
L_nospec_28:
    v_cvt_pk_bf16_f32 v94, v118, v119
    v_cvt_pk_bf16_f32 v95, v120, v121
    s_nop 1
    v_mfma_f32_16x16x32_bf16 v[102:105], v[94:97], v[30:33], 0
    v_mfma_f32_16x16x32_bf16 v[106:109], v[94:97], v[34:37], 0
    v_pk_mul_f32 v[118:119], v[110:111], v[38:39]
    v_pk_mul_f32 v[120:121], v[114:115], v[38:39]
    v_pk_fma_f32 v[118:119], v[114:115], v[42:43], v[118:119] neg_lo:[1,0,0] neg_hi:[1,0,0]
    v_pk_fma_f32 v[120:121], v[110:111], v[42:43], v[120:121]
    v_cvt_pk_bf16_f32 v144, v118, v119
    v_cvt_pk_bf16_f32 v146, v120, v121
    v_pk_mul_f32 v[118:119], v[112:113], v[40:41]
    v_pk_mul_f32 v[120:121], v[116:117], v[40:41]
    v_pk_fma_f32 v[118:119], v[116:117], v[44:45], v[118:119] neg_lo:[1,0,0] neg_hi:[1,0,0]
    v_pk_fma_f32 v[120:121], v[112:113], v[44:45], v[120:121]
    v_cvt_pk_bf16_f32 v145, v118, v119
    v_cvt_pk_bf16_f32 v147, v120, v121
    s_nop 1
    v_mfma_f32_16x16x32_bf16 v[132:135], v[144:147], v[48:51], 0
    v_mfma_f32_16x16x32_bf16 v[136:139], v[144:147], v[46:49], 0
    v_pk_mul_f32 v[118:119], v[102:103], v[38:39]
    v_pk_mul_f32 v[120:121], v[106:107], v[38:39]
    v_pk_fma_f32 v[118:119], v[106:107], v[42:43], v[118:119] neg_lo:[1,0,0] neg_hi:[1,0,0]
    v_pk_fma_f32 v[120:121], v[102:103], v[42:43], v[120:121]
    v_cvt_pk_bf16_f32 v140, v118, v119
    v_cvt_pk_bf16_f32 v142, v120, v121
    v_pk_mul_f32 v[118:119], v[104:105], v[40:41]
    v_pk_mul_f32 v[120:121], v[108:109], v[40:41]
    v_pk_fma_f32 v[118:119], v[108:109], v[44:45], v[118:119] neg_lo:[1,0,0] neg_hi:[1,0,0]
    v_pk_fma_f32 v[120:121], v[104:105], v[44:45], v[120:121]
    v_cvt_pk_bf16_f32 v141, v118, v119
    v_cvt_pk_bf16_f32 v143, v120, v121
    s_nop 1
    v_mfma_f32_16x16x32_bf16 v[124:127], v[140:143], v[48:51], 0
    v_mfma_f32_16x16x32_bf16 v[128:131], v[140:143], v[46:49], 0
    v_cvt_pk_bf16_f32 v95, v132, v133
    v_cvt_pk_bf16_f32 v97, v136, v137
    v_cvt_pk_bf16_f32 v99, v134, v135
    v_cvt_pk_bf16_f32 v101, v138, v139
    s_nop 2
    v_cvt_pk_bf16_f32 v94, v124, v125
    v_cvt_pk_bf16_f32 v96, v128, v129
    ds_write_b128 v14, v[94:97] offset:43712
    v_cvt_pk_bf16_f32 v98, v126, v127
    v_cvt_pk_bf16_f32 v100, v130, v131
    ds_write_b128 v14, v[98:101] offset:43840
    s_waitcnt lgkmcnt(0)
    s_barrier
    ds_read_b128 v[94:97], v15 offset:43712
    ds_read_b128 v[98:101], v15 offset:51904
    s_waitcnt lgkmcnt(1)
    v_bfi_b32 v94, 1, v60, v94
    buffer_store_dwordx4 v[94:97], v9, s[32:35], s60 offen sc1
    s_waitcnt lgkmcnt(0)
    v_bfi_b32 v98, 1, v61, v98
    buffer_store_dwordx4 v[98:101], v9, s[32:35], s61 offen sc1
    s_setprio 0
    s_branch L_bp3_23
L_bhelp_22:
    s_waitcnt vmcnt(0)
    v_add_u32 v6, 1, v6
    ds_write_b32 v8, v6 offset:27656
    s_waitcnt lgkmcnt(0)
    s_barrier
    s_lshl_b32 s38, s36, 10
    s_add_u32 s38, s38, 4194304
    v_lshlrev_b32 v9, 4, v1
    v_mov_b32 v12, v6
    v_mov_b32 v13, v6
    v_mov_b32 v14, v6
    v_mov_b32 v15, v6
    buffer_store_dwordx4 v[12:15], v9, s[32:35], s38 offen sc1
    s_cmp_lg_u32 s62, 0
    s_cbranch_scc1 L_nospec_29
    s_lshr_b32 s43, s36, 4
    s_cmp_lg_u32 s43, 0
    s_cselect_b32 s38, s53, -1
    s_cmp_gt_i32 s38, 0
    s_cselect_b32 s39, -1, 1
    s_cselect_b32 s40, 2056, 1
    s_lshl_b32 s40, s40, 9
    s_mul_i32 s39, s39, 514
    v_lshl_add_u32 v10, v3, 5, v2
    v_lshl_add_u32 v9, v10, 4, s51
    v_mov_b32 v12, s40
    v_mad_i32_i24 v9, v9, s39, v12
    s_lshl_b32 s39, s39, 8
    v_add_u32 v12, s39, v9
    global_load_ushort v28, v9, s[24:25]
    global_load_ushort v29, v9, s[26:27]
    global_load_ushort v30, v12, s[24:25]
    global_load_ushort v31, v12, s[26:27]
    s_lshr_b32 s39, s55, 1
    s_and_b32 s40, s55, 1
    s_mul_i32 s40, s40, 14
    s_add_u32 s40, s40, 60096
    v_lshrrev_b32 v9, 2, v2
    v_xor_b32 v9, s39, v9
    v_lshl_add_u32 v10, v10, 6, s40
    v_lshl_add_u32 v9, v9, 4, v10
    ds_read_u16 v24, v9 offset:0
    ds_read_u16 v25, v9 offset:8192
    ds_read_u16 v26, v9 offset:1024
    ds_read_u16 v27, v9 offset:9216
    s_lshr_b32 s39, s51, 3
    s_sub_u32 s39, 128, s39
    v_lshl_add_u32 v9, v3, 5, v2
    v_sub_u32 v9, s39, v9
    v_and_b32 v10, 15, v9
    v_bfe_u32 v22, v9, 4, 1
    v_bfe_u32 v9, v9, 5, 2
    v_lshl_add_u32 v10, v9, 4, v10
    v_lshlrev_b32 v20, 2, v10
    v_lshl_add_u32 v9, v3, 5, v2
    v_sub_u32 v9, s39, v9
    v_add_u32 v9, -16, v9
    v_and_b32 v10, 15, v9
    v_bfe_u32 v23, v9, 4, 1
    v_bfe_u32 v9, v9, 5, 2
    v_lshl_add_u32 v10, v9, 4, v10
    v_lshlrev_b32 v21, 2, v10
    s_waitcnt vmcnt(0) lgkmcnt(0)
    v_lshlrev_b32 v24, 16, v24
    v_lshlrev_b32 v28, 16, v28
    v_lshlrev_b32 v25, 16, v25
    v_lshlrev_b32 v29, 16, v29
    v_lshlrev_b32 v26, 16, v26
    v_lshlrev_b32 v30, 16, v30
    v_lshlrev_b32 v27, 16, v27
    v_lshlrev_b32 v31, 16, v31
    s_cmp_lg_u32 s43, 0
    s_cbranch_scc1 L_s1_30
    ds_bpermute_b32 v32, v20, v24
    ds_bpermute_b32 v36, v20, v28
    ds_bpermute_b32 v33, v20, v25
    ds_bpermute_b32 v37, v20, v29
    ds_bpermute_b32 v34, v20, v26
    ds_bpermute_b32 v38, v20, v30
    ds_bpermute_b32 v35, v20, v27
    ds_bpermute_b32 v39, v20, v31
    s_waitcnt lgkmcnt(0)
    ds_bpermute_b32 v40, v21, v24
    ds_bpermute_b32 v44, v21, v28
    ds_bpermute_b32 v41, v21, v25
    ds_bpermute_b32 v45, v21, v29
    ds_bpermute_b32 v42, v21, v26
    ds_bpermute_b32 v46, v21, v30
    ds_bpermute_b32 v43, v21, v27
    ds_bpermute_b32 v47, v21, v31
    s_waitcnt lgkmcnt(0)
    v_cmp_eq_u32 vcc, 1, v22
    s_nop 1
    v_cndmask_b32 v32, v32, v34, vcc
    v_cndmask_b32 v33, v33, v35, vcc
    v_cndmask_b32 v36, v36, v38, vcc
    v_cndmask_b32 v37, v37, v39, vcc
    v_add_f32 v32, v24, v32
    v_sub_f32 v33, v25, v33
    v_add_f32 v36, v28, v36
    v_sub_f32 v37, v29, v37
    v_add_f32 v12, v32, v36
    v_sub_f32 v16, v32, v36
    v_add_f32 v13, v33, v37
    v_sub_f32 v17, v33, v37
    v_cmp_eq_u32 vcc, 1, v23
    s_nop 1
    v_cndmask_b32 v40, v40, v42, vcc
    v_cndmask_b32 v41, v41, v43, vcc
    v_cndmask_b32 v44, v44, v46, vcc
    v_cndmask_b32 v45, v45, v47, vcc
    v_add_f32 v40, v26, v40
    v_sub_f32 v41, v27, v41
    v_add_f32 v44, v30, v44
    v_sub_f32 v45, v31, v45
    v_add_f32 v14, v40, v44
    v_sub_f32 v18, v40, v44
    v_add_f32 v15, v41, v45
    v_sub_f32 v19, v41, v45
    v_mul_f32 v12, 0x3e000000, v12
    v_mul_f32 v13, 0x3e000000, v13
    v_mul_f32 v14, 0x3e000000, v14
    v_mul_f32 v15, 0x3e000000, v15
    v_mul_f32 v16, 0x3e000000, v16
    v_mul_f32 v17, 0x3e000000, v17
    v_mul_f32 v18, 0x3e000000, v18
    v_mul_f32 v19, 0x3e000000, v19
    s_branch L_specw_31
L_s1_30:
    v_add_f32 v12, v24, v28
    v_sub_f32 v13, v25, v29
    v_mul_f32 v12, 0.5, v12
    v_mul_f32 v13, 0.5, v13
    v_mul_f32 v13, s54, v13
    v_mov_b32 v16, 0
    v_mov_b32 v17, 0
    v_add_f32 v14, v26, v30
    v_sub_f32 v15, v27, v31
    v_mul_f32 v14, 0.5, v14
    v_mul_f32 v15, 0.5, v15
    v_mul_f32 v15, s54, v15
    v_mov_b32 v18, 0
    v_mov_b32 v19, 0
L_specw_31:
    ds_write_b128 v8, v[12:15] offset:28672
    ds_write_b128 v8, v[16:19] offset:29696
    ds_write_b128 v8, v[20:23] offset:30720
L_nospec_29:
    s_waitcnt lgkmcnt(0)
    s_barrier
    s_cmp_lg_u32 s36, 0
    s_cbranch_scc1 L_noepoch_32
    v_mov_b32 v9, 4456448
    s_mov_b64 exec, 1
    buffer_store_dword v6, v9, s[32:35], 0 offen sc1
    s_mov_b64 exec, -1
L_noepoch_32:
    s_barrier
L_bp3_23:
    ds_read_b128 v[36:39], v8 offset:7168
    ds_read_b128 v[44:47], v8 offset:8192
    ds_read_b128 v[52:55], v8 offset:9216
    ds_read_b128 v[40:43], v8 offset:10240
    ds_read_b128 v[48:51], v8 offset:11264
    ds_read_b128 v[56:59], v8 offset:12288
    ds_read_b128 v[12:15], v8 offset:22528
    ds_read_b128 v[20:23], v8 offset:24576
    ds_read_b128 v[16:19], v8 offset:23552
    ds_read_b128 v[24:27], v8 offset:25600
    ds_read_b128 v[28:31], v8 offset:26624
    ds_read_b64 v[32:33], v8 offset:27648
    ds_read_b64 v[34:35], v8 offset:8
    s_mul_i32 s38, s37, 2560
    v_mul_u32_u24 v9, 40, v2
    v_lshl_add_u32 v9, v3, 3, v9
    v_add_u32 v9, s38, v9
    v_lshl_add_u32 v65, v3, 2, v11
    v_mul_u32_u24 v10, 40, v65
    v_lshl_add_u32 v10, v62, 3, v10
    v_add_u32 v10, s38, v10
    s_mul_i32 s38, s44, 1216
    s_mul_i32 s39, s45, 1216
    v_mul_u32_u24 v60, 72, v2
    v_lshl_add_u32 v60, v3, 3, v60
    v_add_u32 v61, s39, v60
    v_add_u32 v60, s38, v60
    s_mul_i32 s38, s37, 144
    v_mul_u32_u24 v63, 1216, v65
    v_lshl_add_u32 v63, v62, 4, v63
    v_add_u32 v63, s38, v63
    s_lshl_b32 s38, s36, 11
    s_lshl_b32 s39, s37, 7
    s_add_u32 s38, s38, s39
    s_add_u32 s38, s38, 1024
    v_lshlrev_b32 v64, 18, v2
    v_lshl_add_u32 v64, v3, 4, v64
    v_add_u32 v64, s38, v64
    s_waitcnt vmcnt(0) lgkmcnt(0)
    s_sleep 2
    s_mov_b32 s38, 0
L_poll_33:
    buffer_load_dwordx4 v[70:73], v67, s[32:35], s46 offen sc1
    buffer_load_dwordx4 v[74:77], v67, s[32:35], s47 offen sc1
    s_add_u32 s38, s38, 1
    s_waitcnt vmcnt(0)
    v_xor_b32 v66, v70, v69
    v_xor_b32 v68, v74, v122
    v_and_b32 v66, v66, v68
    v_and_b32 v66, 1, v66
    v_cmp_eq_u32 vcc, 0, v66
    s_nop 0
    s_cbranch_vccz L_polled_34
    s_mov_b64 exec, vcc
    s_cmp_lt_u32 s38, 400000
    s_cbranch_scc1 L_poll_33
L_polled_34:
    s_mov_b64 exec, -1
    v_and_b32 v65, 0xffff, v72
    v_cndmask_b32 v74, v74, v65, s[48:49]
    ds_write_b64 v9, v[70:71] offset:0
    ds_write_b64 v9, v[74:75] offset:640
    ds_write_b64 v9, v[72:73] offset:1280
    ds_write_b64 v9, v[76:77] offset:1920
    ds_read_b64_tr_b16 v[78:79], v10 offset:0
    ds_read_b64_tr_b16 v[80:81], v10 offset:640
    ds_read_b64_tr_b16 v[82:83], v10 offset:1280
    ds_read_b64_tr_b16 v[84:85], v10 offset:1920
    s_waitcnt lgkmcnt(2)
    v_mfma_f32_16x16x32_bf16 v[86:89], v[78:81], v[36:39], 0
    v_mfma_f32_16x16x32_bf16 v[90:93], v[78:81], v[44:47], 0
    s_waitcnt lgkmcnt(0)
    v_mfma_f32_16x16x32_bf16 v[86:89], v[82:85], v[52:55], v[86:89]
    v_mfma_f32_16x16x32_bf16 v[90:93], v[82:85], v[36:39], v[90:93]
    v_mfma_f32_16x16x32_bf16 v[94:97], v[78:81], v[40:43], 0
    v_mfma_f32_16x16x32_bf16 v[98:101], v[78:81], v[48:51], 0
    v_mfma_f32_16x16x32_bf16 v[94:97], v[82:85], v[56:59], v[94:97]
    v_mfma_f32_16x16x32_bf16 v[98:101], v[82:85], v[40:43], v[98:101]
    s_nop 2
    v_pk_mul_f32 v[118:119], v[86:87], v[12:13]
    v_pk_mul_f32 v[120:121], v[90:91], v[12:13]
    v_pk_fma_f32 v[118:119], v[90:91], v[20:21], v[118:119] neg_lo:[1,0,0] neg_hi:[1,0,0]
    v_pk_fma_f32 v[120:121], v[86:87], v[20:21], v[120:121]
    v_cvt_pk_bf16_f32 v70, v118, v119
    v_cvt_pk_bf16_f32 v72, v120, v121
    v_pk_mul_f32 v[118:119], v[88:89], v[14:15]
    v_pk_mul_f32 v[120:121], v[92:93], v[14:15]
    v_pk_fma_f32 v[118:119], v[92:93], v[22:23], v[118:119] neg_lo:[1,0,0] neg_hi:[1,0,0]
    v_pk_fma_f32 v[120:121], v[88:89], v[22:23], v[120:121]
    v_cvt_pk_bf16_f32 v71, v118, v119
    v_cvt_pk_bf16_f32 v73, v120, v121
    s_nop 1
    v_mfma_f32_16x16x32_bf16 v[102:105], v[70:73], v[30:33], 0
    v_mfma_f32_16x16x32_bf16 v[106:109], v[70:73], v[28:31], 0
    v_pk_mul_f32 v[118:119], v[94:95], v[16:17]
    v_pk_mul_f32 v[120:121], v[98:99], v[16:17]
    v_pk_fma_f32 v[118:119], v[98:99], v[24:25], v[118:119] neg_lo:[1,0,0] neg_hi:[1,0,0]
    v_pk_fma_f32 v[120:121], v[94:95], v[24:25], v[120:121]
    v_cvt_pk_bf16_f32 v74, v118, v119
    v_cvt_pk_bf16_f32 v76, v120, v121
    v_pk_mul_f32 v[118:119], v[96:97], v[18:19]
    v_pk_mul_f32 v[120:121], v[100:101], v[18:19]
    v_pk_fma_f32 v[118:119], v[100:101], v[26:27], v[118:119] neg_lo:[1,0,0] neg_hi:[1,0,0]
    v_pk_fma_f32 v[120:121], v[96:97], v[26:27], v[120:121]
    v_cvt_pk_bf16_f32 v75, v118, v119
    v_cvt_pk_bf16_f32 v77, v120, v121
    s_nop 1
    v_mfma_f32_16x16x32_bf16 v[110:113], v[74:77], v[30:33], 0
    v_mfma_f32_16x16x32_bf16 v[114:117], v[74:77], v[28:31], 0
    v_cvt_pk_bf16_f32 v78, v102, v103
    v_cvt_pk_bf16_f32 v79, v104, v105
    ds_write_b64 v60, v[78:79] offset:23040
    v_cvt_pk_bf16_f32 v80, v106, v107
    v_cvt_pk_bf16_f32 v81, v108, v109
    ds_write_b64 v61, v[80:81] offset:23040
    s_nop 0
    v_cvt_pk_bf16_f32 v82, v110, v111
    v_cvt_pk_bf16_f32 v83, v112, v113
    ds_write_b64 v60, v[82:83] offset:23072
    v_cvt_pk_bf16_f32 v84, v114, v115
    v_cvt_pk_bf16_f32 v85, v116, v117
    ds_write_b64 v61, v[84:85] offset:23072
    s_waitcnt lgkmcnt(0)
    s_barrier
    s_cmp_eq_u32 s37, 8
    s_cbranch_scc1 L_fin
    ds_read_b64_tr_b16 v[78:79], v63 offset:23040
    ds_read_b64_tr_b16 v[80:81], v63 offset:23048
    ds_read_b64_tr_b16 v[82:83], v63 offset:23112
    ds_read_b64_tr_b16 v[84:85], v63 offset:23120
    s_waitcnt lgkmcnt(3)
    v_mfma_f32_16x16x16_bf16 v[86:89], v[78:79], v[34:35], 0
    s_waitcnt lgkmcnt(2)
    v_mfma_f32_16x16x16_bf16 v[90:93], v[80:81], v[34:35], 0
    s_waitcnt lgkmcnt(1)
    v_mfma_f32_16x16x16_bf16 v[94:97], v[82:83], v[34:35], 0
    s_waitcnt lgkmcnt(0)
    v_mfma_f32_16x16x16_bf16 v[98:101], v[84:85], v[34:35], 0
    s_nop 1
    v_cvt_pk_bf16_f32 v70, v86, v87
    v_cvt_pk_bf16_f32 v71, v88, v89
    v_cvt_pk_bf16_f32 v72, v90, v91
    v_cvt_pk_bf16_f32 v73, v92, v93
    global_store_dwordx4 v64, v[70:73], s[28:29] offset:0 sc1
    v_cvt_pk_bf16_f32 v74, v94, v95
    v_cvt_pk_bf16_f32 v75, v96, v97
    v_cvt_pk_bf16_f32 v76, v98, v99
    v_cvt_pk_bf16_f32 v77, v100, v101
    global_store_dwordx4 v64, v[74:77], s[28:29] offset:64 sc1
    s_branch L_fin
.p2align 6
L_conv:
    s_cmp_eq_u32 s37, 8
    s_cbranch_scc1 L_ahelp_35
    s_and_b32 s44, s37, 3
    s_lshr_b32 s45, s37, 2
    v_and_b32 v22, 1, v3
    v_lshrrev_b32 v23, 1, v3
    v_bfe_u32 v27, v1, 2, 2
    v_and_b32 v28, 3, v1
    v_lshlrev_b32 v15, 1, v27
    v_and_b32 v15, 4, v15
    v_lshl_add_u32 v15, v22, 1, v15
    v_lshrrev_b32 v21, 1, v28
    v_lshl_add_u32 v21, v23, 1, v21
    v_xor_b32 v15, v15, v21
    v_lshlrev_b32 v29, 4, v15
    v_and_b32 v15, 1, v28
    v_lshl_add_u32 v29, v15, 3, v29
    v_lshl_add_u32 v15, v22, 3, v27
    v_lshl_add_u32 v29, v15, 7, v29
    v_add_u32 v29, s41, v29
    v_xor_b32 v30, 64, v29
    v_lshrrev_b32 v15, 2, v2
    v_lshl_add_u32 v15, v23, 2, v15
    v_lshlrev_b32 v31, 7, v15
    v_lshl_add_u32 v31, v22, 6, v31
    v_and_b32 v15, 3, v2
    v_lshl_add_u32 v31, v15, 4, v31
    s_lshl_b32 s46, s36, 14
    s_add_u32 s46, s46, s41
    s_add_u32 s46, s46, 2097152
    s_lshl_b32 s60, s36, 7
    s_add_u32 s60, s60, 2097152
    s_add_u32 s61, s60, 0x100000
    s_mov_b32 s48, 4640
    v_lshrrev_b32 v15, 7, v0
    v_mul_u32_u24 v33, 4640, v15
    v_and_b32 v21, 127, v0
    v_lshl_add_u32 v33, v21, 2, v33
    v_mov_b32 v21, 0
    v_mul_u32_u24 v15, 3104, v15
    ds_write_b32 v33, v21 offset:16384
    ds_write_b32 v15, v21 offset:35328
    ds_write_b32 v15, v21 offset:47872
    ds_write_b32 v15, v21 offset:48260
    v_mov_b32 v21, 1.0
    ds_write_b32 v15, v21 offset:35716
    s_mul_i32 s47, s37, 4608
    s_add_u32 s38, s47, 59904
    s_add_u32 s47, s47, 16384
    v_mul_u32_u24 v32, 288, v2
    v_lshl_add_u32 v32, v3, 4, v32
    v_add_u32 v32, s38, v32
    s_mul_i32 s38, s44, 3104
    s_mul_i32 s39, s45, 12544
    s_add_u32 s38, s38, s39
    s_add_u32 s38, s38, 34944
    v_mul_u32_u24 v15, 388, v22
    v_lshl_add_u32 v15, v23, 4, v15
    v_add_u32 v15, v15, v2
    v_lshl_add_u32 v34, v15, 2, s38
    v_add_u32 v21, 1, v23
    v_lshrrev_b32 v15, v21, v2
    v_lshl_add_u32 v15, v3, 3, v15
    v_sub_u32 v21, 2, v23
    v_lshlrev_b32 v21, v21, v2
    v_and_b32 v21, 7, v21
    v_mul_u32_u24 v21, 97, v21
    v_add3_u32 v15, v15, v21, 32
    v_lshl_add_u32 v35, v15, 2, s38
    v_mul_u32_u24 v15, 760, v23
    v_sub_u32 v15, 776, v15
    v_add_u32 v36, v35, v15
    v_and_b32 v15, 7, v2
    v_mul_u32_u24 v15, 97, v15
    v_lshrrev_b32 v21, 3, v2
    v_lshl_add_u32 v21, v3, 3, v21
    v_add3_u32 v15, v15, v21, 64
    v_lshl_add_u32 v37, v15, 2, s38
    s_lshl_b32 s38, s44, 8
    s_lshl_b32 s39, s45, 7
    s_add_u32 s38, s38, s39
    s_add_u32 s38, s38, 113408
    v_lshl_add_u32 v33, v1, 1, s38
    s_lshl_b32 s38, s36, 2
    s_add_u32 s38, s38, s44
    s_lshl_b32 s38, s38, 1
    s_add_u32 s38, s38, 119552
    v_mov_b32 v24, s38
    s_lshl_b32 s38, s37, 7
    s_add_u32 s38, s38, 120576
    v_lshl_add_u32 v15, v23, 4, v2
    v_lshl_add_u32 v25, v15, 1, s38
    s_setprio 2
    s_mov_b32 m0, s47
    s_waitcnt vmcnt(0)
    ds_read_b64_tr_b16 v[38:39], v29 offset:0
    ds_read_b64_tr_b16 v[40:41], v29 offset:512
    ds_read_b64_tr_b16 v[42:43], v30 offset:0
    ds_read_b64_tr_b16 v[44:45], v30 offset:512
    s_waitcnt lgkmcnt(2)
    buffer_store_dwordx4 v[38:41], v31, s[32:35], s46 offen offset:0 sc1
    s_waitcnt lgkmcnt(0)
    buffer_store_dwordx4 v[42:45], v31, s[32:35], s46 offen offset:1024 sc1
    s_setprio 0
    s_barrier
    ds_read_u16 v14, v24
    ds_read_u16 v8, v33 offset:0
    ds_read_u16 v9, v33 offset:1024
    ds_read_u16 v10, v33 offset:2048
    ds_read_u16 v11, v33 offset:3072
    ds_read_u16 v12, v33 offset:4096
    ds_read_u16 v13, v33 offset:5120
    ds_read_u16 v4, v25
    ds_read_u16 v5, v25 offset:64
    v_lshlrev_b32 v15, 4, v0
    s_mov_b32 s38, L_tab-L_pc
    buffer_load_dwordx4 v[16:19], v15, s[92:95], s38 offen
    buffer_load_ushort v20, v15, s[92:95], s38 offen offset:16
    s_waitcnt lgkmcnt(2)
    v_lshlrev_b32 v8, 16, v8
    v_lshlrev_b32 v9, 16, v9
    v_lshlrev_b32 v10, 16, v10
    v_lshlrev_b32 v11, 16, v11
    v_lshlrev_b32 v12, 16, v12
    v_lshlrev_b32 v13, 16, v13
    v_lshlrev_b32 v14, 16, v14
    s_mov_b32 s38, 0x3fb8aa3b
    v_mul_f32 v15, s38, v14
    v_fma_f32 v21, v14, s38, -v15
    v_fmamk_f32 v21, v14, 0x32a57060, v21
    v_exp_f32 v15, v15
    v_mul_f32 v21, 0x3f317218, v21
    v_fma_f32 v15, v15, v21, v15
    v_cvt_pk_bf16_f32 v14, v15, v15
    v_and_b32 v14, 0xffff0000, v14
    v_mul_f32 v8, v14, v8
    v_mul_f32 v9, v14, v9
    v_mul_f32 v10, v14, v10
    v_mul_f32 v11, v14, v11
    v_mul_f32 v8, s38, v8
    v_mul_f32 v9, 0.15915494, v9
    v_mul_f32 v52, v12, v10
    v_mul_f32 v53, v13, v10
    v_fma_f32 v52, -v13, v11, v52
    v_fmac_f32 v53, v12, v11
    v_mul_f32 v15, 0x41000000, v8
    v_mul_f32 v21, 0x41000000, v9
    v_exp_f32 v15, v15
    v_fract_f32 v21, v21
    v_cos_f32 v48, v21
    v_sin_f32 v49, v21
    v_mul_f32 v48, v15, v48
    v_mul_f32 v49, v15, v49
    v_mul_f32 v15, 0x3f800000, v8
    v_mul_f32 v21, 0x3f800000, v9
    v_exp_f32 v15, v15
    v_fract_f32 v21, v21
    v_cos_f32 v46, v21
    v_sin_f32 v47, v21
    v_mul_f32 v46, v15, v46
    v_mul_f32 v47, v15, v47
    v_mul_f32 v15, 0x43000000, v8
    v_mul_f32 v21, 0x43000000, v9
    v_exp_f32 v15, v15
    v_fract_f32 v21, v21
    v_cos_f32 v50, v21
    v_sin_f32 v51, v21
    v_mul_f32 v50, v15, v50
    v_mul_f32 v51, v15, v51
    v_mov_b32 v68, 0x3f80
    ds_write_addtid_b32 v68 offset:43520
    v_cvt_pk_bf16_f32 v69, v48, -v49
    v_pk_mul_f32 v[70:71], v[48:49], v[48:49] op_sel:[1,1] op_sel_hi:[0,1]
    ds_write_addtid_b32 v69 offset:43808
    v_pk_fma_f32 v[72:73], v[48:49], v[48:49], v[70:71] op_sel_hi:[1,0,1] neg_lo:[0,0,1]
    v_cvt_pk_bf16_f32 v68, v72, -v73
    v_pk_mul_f32 v[70:71], v[72:73], v[48:49] op_sel:[1,1] op_sel_hi:[0,1]
    ds_write_addtid_b32 v68 offset:44096
    v_pk_fma_f32 v[72:73], v[72:73], v[48:49], v[70:71] op_sel_hi:[1,0,1] neg_lo:[0,0,1]
    v_cvt_pk_bf16_f32 v69, v72, -v73
    v_pk_mul_f32 v[70:71], v[72:73], v[48:49] op_sel:[1,1] op_sel_hi:[0,1]
    ds_write_addtid_b32 v69 offset:44384
    v_pk_fma_f32 v[72:73], v[72:73], v[48:49], v[70:71] op_sel_hi:[1,0,1] neg_lo:[0,0,1]
    v_cvt_pk_bf16_f32 v68, v72, -v73
    v_pk_mul_f32 v[70:71], v[72:73], v[48:49] op_sel:[1,1] op_sel_hi:[0,1]
    ds_write_addtid_b32 v68 offset:44672
    v_pk_fma_f32 v[72:73], v[72:73], v[48:49], v[70:71] op_sel_hi:[1,0,1] neg_lo:[0,0,1]
    v_cvt_pk_bf16_f32 v69, v72, -v73
    v_pk_mul_f32 v[70:71], v[72:73], v[48:49] op_sel:[1,1] op_sel_hi:[0,1]
    ds_write_addtid_b32 v69 offset:44960
    v_pk_fma_f32 v[72:73], v[72:73], v[48:49], v[70:71] op_sel_hi:[1,0,1] neg_lo:[0,0,1]
    v_cvt_pk_bf16_f32 v68, v72, -v73
    v_pk_mul_f32 v[70:71], v[72:73], v[48:49] op_sel:[1,1] op_sel_hi:[0,1]
    ds_write_addtid_b32 v68 offset:45248
    v_pk_fma_f32 v[72:73], v[72:73], v[48:49], v[70:71] op_sel_hi:[1,0,1] neg_lo:[0,0,1]
    v_cvt_pk_bf16_f32 v69, v72, -v73
    v_pk_mul_f32 v[70:71], v[72:73], v[48:49] op_sel:[1,1] op_sel_hi:[0,1]
    ds_write_addtid_b32 v69 offset:45536
    v_pk_fma_f32 v[72:73], v[72:73], v[48:49], v[70:71] op_sel_hi:[1,0,1] neg_lo:[0,0,1]
    v_cvt_pk_bf16_f32 v68, v72, -v73
    v_pk_mul_f32 v[70:71], v[72:73], v[48:49] op_sel:[1,1] op_sel_hi:[0,1]
    ds_write_addtid_b32 v68 offset:45824
    v_pk_fma_f32 v[72:73], v[72:73], v[48:49], v[70:71] op_sel_hi:[1,0,1] neg_lo:[0,0,1]
    v_cvt_pk_bf16_f32 v69, v72, -v73
    v_pk_mul_f32 v[70:71], v[72:73], v[48:49] op_sel:[1,1] op_sel_hi:[0,1]
    ds_write_addtid_b32 v69 offset:46112
    v_pk_fma_f32 v[72:73], v[72:73], v[48:49], v[70:71] op_sel_hi:[1,0,1] neg_lo:[0,0,1]
    v_cvt_pk_bf16_f32 v68, v72, -v73
    v_pk_mul_f32 v[70:71], v[72:73], v[48:49] op_sel:[1,1] op_sel_hi:[0,1]
    ds_write_addtid_b32 v68 offset:46400
    v_pk_fma_f32 v[72:73], v[72:73], v[48:49], v[70:71] op_sel_hi:[1,0,1] neg_lo:[0,0,1]
    v_cvt_pk_bf16_f32 v69, v72, -v73
    v_pk_mul_f32 v[70:71], v[72:73], v[48:49] op_sel:[1,1] op_sel_hi:[0,1]
    ds_write_addtid_b32 v69 offset:46688
    v_pk_fma_f32 v[72:73], v[72:73], v[48:49], v[70:71] op_sel_hi:[1,0,1] neg_lo:[0,0,1]
    v_cvt_pk_bf16_f32 v68, v72, -v73
    v_pk_mul_f32 v[70:71], v[72:73], v[48:49] op_sel:[1,1] op_sel_hi:[0,1]
    ds_write_addtid_b32 v68 offset:46976
    v_pk_fma_f32 v[72:73], v[72:73], v[48:49], v[70:71] op_sel_hi:[1,0,1] neg_lo:[0,0,1]
    v_cvt_pk_bf16_f32 v69, v72, -v73
    v_pk_mul_f32 v[70:71], v[72:73], v[48:49] op_sel:[1,1] op_sel_hi:[0,1]
    ds_write_addtid_b32 v69 offset:47264
    v_pk_fma_f32 v[72:73], v[72:73], v[48:49], v[70:71] op_sel_hi:[1,0,1] neg_lo:[0,0,1]
    v_cvt_pk_bf16_f32 v68, v72, -v73
    v_pk_mul_f32 v[70:71], v[72:73], v[48:49] op_sel:[1,1] op_sel_hi:[0,1]
    ds_write_addtid_b32 v68 offset:47552
    v_pk_fma_f32 v[72:73], v[72:73], v[48:49], v[70:71] op_sel_hi:[1,0,1] neg_lo:[0,0,1]
    v_cvt_pk_bf16_f32 v69, v72, -v73
    ds_write_addtid_b32 v69 offset:47840
    ds_read_b128 v[74:77], v32 offset:0
    ds_read_b128 v[78:81], v32 offset:64
    ds_read_b128 v[82:85], v32 offset:128
    ds_read_b128 v[86:89], v32 offset:192
    v_cvt_pk_bf16_f32 v68, v52, v53
    v_pk_mul_f32 v[70:71], v[52:53], v[46:47] op_sel:[1,1] op_sel_hi:[0,1]
    ds_write_addtid_b32 v68 offset:43520
    v_pk_fma_f32 v[54:55], v[52:53], v[46:47], v[70:71] op_sel_hi:[1,0,1] neg_lo:[0,0,1]
    v_cvt_pk_bf16_f32 v69, v54, v55
    v_pk_mul_f32 v[70:71], v[54:55], v[46:47] op_sel:[1,1] op_sel_hi:[0,1]
    ds_write_addtid_b32 v69 offset:43808
    v_pk_fma_f32 v[56:57], v[54:55], v[46:47], v[70:71] op_sel_hi:[1,0,1] neg_lo:[0,0,1]
    v_cvt_pk_bf16_f32 v68, v56, v57
    v_pk_mul_f32 v[70:71], v[56:57], v[46:47] op_sel:[1,1] op_sel_hi:[0,1]
    ds_write_addtid_b32 v68 offset:44096
    v_pk_fma_f32 v[58:59], v[56:57], v[46:47], v[70:71] op_sel_hi:[1,0,1] neg_lo:[0,0,1]
    v_cvt_pk_bf16_f32 v69, v58, v59
    v_pk_mul_f32 v[70:71], v[58:59], v[46:47] op_sel:[1,1] op_sel_hi:[0,1]
    ds_write_addtid_b32 v69 offset:44384
    v_pk_fma_f32 v[60:61], v[58:59], v[46:47], v[70:71] op_sel_hi:[1,0,1] neg_lo:[0,0,1]
    v_cvt_pk_bf16_f32 v68, v60, v61
    s_waitcnt vmcnt(0)
    s_barrier
    v_pk_mul_f32 v[70:71], v[60:61], v[46:47] op_sel:[1,1] op_sel_hi:[0,1]
    ds_write_addtid_b32 v68 offset:44672
    v_pk_fma_f32 v[62:63], v[60:61], v[46:47], v[70:71] op_sel_hi:[1,0,1] neg_lo:[0,0,1]
    v_cvt_pk_bf16_f32 v69, v62, v63
    v_pk_mul_f32 v[70:71], v[62:63], v[46:47] op_sel:[1,1] op_sel_hi:[0,1]
    ds_write_addtid_b32 v69 offset:44960
    v_pk_fma_f32 v[64:65], v[62:63], v[46:47], v[70:71] op_sel_hi:[1,0,1] neg_lo:[0,0,1]
    v_cvt_pk_bf16_f32 v68, v64, v65
    v_pk_mul_f32 v[70:71], v[64:65], v[46:47] op_sel:[1,1] op_sel_hi:[0,1]
    ds_write_addtid_b32 v68 offset:45248
    v_pk_fma_f32 v[66:67], v[64:65], v[46:47], v[70:71] op_sel_hi:[1,0,1] neg_lo:[0,0,1]
    v_cvt_pk_bf16_f32 v69, v66, v67
    v_pk_mul_f32 v[70:71], v[52:53], v[50:51] op_sel:[1,1] op_sel_hi:[0,1]
    ds_write_addtid_b32 v69 offset:45536
    v_pk_fma_f32 v[52:53], v[52:53], v[50:51], v[70:71] op_sel_hi:[1,0,1] neg_lo:[0,0,1]
    v_cvt_pk_bf16_f32 v68, v52, v53
    v_pk_mul_f32 v[70:71], v[54:55], v[50:51] op_sel:[1,1] op_sel_hi:[0,1]
    ds_write_addtid_b32 v68 offset:45824
    v_pk_fma_f32 v[54:55], v[54:55], v[50:51], v[70:71] op_sel_hi:[1,0,1] neg_lo:[0,0,1]
    v_cvt_pk_bf16_f32 v69, v54, v55
    v_pk_mul_f32 v[70:71], v[56:57], v[50:51] op_sel:[1,1] op_sel_hi:[0,1]
    ds_write_addtid_b32 v69 offset:46112
    v_pk_fma_f32 v[56:57], v[56:57], v[50:51], v[70:71] op_sel_hi:[1,0,1] neg_lo:[0,0,1]
    v_cvt_pk_bf16_f32 v68, v56, v57
    v_pk_mul_f32 v[70:71], v[58:59], v[50:51] op_sel:[1,1] op_sel_hi:[0,1]
    ds_write_addtid_b32 v68 offset:46400
    v_pk_fma_f32 v[58:59], v[58:59], v[50:51], v[70:71] op_sel_hi:[1,0,1] neg_lo:[0,0,1]
    v_cvt_pk_bf16_f32 v69, v58, v59
    v_pk_mul_f32 v[70:71], v[60:61], v[50:51] op_sel:[1,1] op_sel_hi:[0,1]
    ds_write_addtid_b32 v69 offset:46688
    v_pk_fma_f32 v[60:61], v[60:61], v[50:51], v[70:71] op_sel_hi:[1,0,1] neg_lo:[0,0,1]
    v_cvt_pk_bf16_f32 v68, v60, v61
    v_pk_mul_f32 v[70:71], v[62:63], v[50:51] op_sel:[1,1] op_sel_hi:[0,1]
    ds_write_addtid_b32 v68 offset:46976
    v_pk_fma_f32 v[62:63], v[62:63], v[50:51], v[70:71] op_sel_hi:[1,0,1] neg_lo:[0,0,1]
    v_cvt_pk_bf16_f32 v69, v62, v63
    v_pk_mul_f32 v[70:71], v[64:65], v[50:51] op_sel:[1,1] op_sel_hi:[0,1]
    ds_write_addtid_b32 v69 offset:47264
    v_pk_fma_f32 v[64:65], v[64:65], v[50:51], v[70:71] op_sel_hi:[1,0,1] neg_lo:[0,0,1]
    v_cvt_pk_bf16_f32 v68, v64, v65
    v_pk_mul_f32 v[70:71], v[66:67], v[50:51] op_sel:[1,1] op_sel_hi:[0,1]
    ds_write_addtid_b32 v68 offset:47552
    v_pk_fma_f32 v[66:67], v[66:67], v[50:51], v[70:71] op_sel_hi:[1,0,1] neg_lo:[0,0,1]
    v_cvt_pk_bf16_f32 v69, v66, v67
    ds_write_addtid_b32 v69 offset:47840
    ds_read_b128 v[90:93], v32 offset:0
    ds_read_b128 v[94:97], v32 offset:64
    ds_read_b128 v[98:101], v32 offset:128
    ds_read_b128 v[102:105], v32 offset:192
    v_pk_mul_f32 v[70:71], v[52:53], v[50:51] op_sel:[1,1] op_sel_hi:[0,1]
    v_pk_fma_f32 v[52:53], v[52:53], v[50:51], v[70:71] op_sel_hi:[1,0,1] neg_lo:[0,0,1]
    v_cvt_pk_bf16_f32 v68, v52, v53
    v_pk_mul_f32 v[70:71], v[56:57], v[50:51] op_sel:[1,1] op_sel_hi:[0,1]
    ds_write_addtid_b32 v68 offset:43520
    v_pk_fma_f32 v[56:57], v[56:57], v[50:51], v[70:71] op_sel_hi:[1,0,1] neg_lo:[0,0,1]
    v_cvt_pk_bf16_f32 v69, v56, v57
    v_pk_mul_f32 v[70:71], v[60:61], v[50:51] op_sel:[1,1] op_sel_hi:[0,1]
    ds_write_addtid_b32 v69 offset:43808
    v_pk_fma_f32 v[60:61], v[60:61], v[50:51], v[70:71] op_sel_hi:[1,0,1] neg_lo:[0,0,1]
    v_cvt_pk_bf16_f32 v68, v60, v61
    v_pk_mul_f32 v[70:71], v[64:65], v[50:51] op_sel:[1,1] op_sel_hi:[0,1]
    ds_write_addtid_b32 v68 offset:44096
    v_pk_fma_f32 v[64:65], v[64:65], v[50:51], v[70:71] op_sel_hi:[1,0,1] neg_lo:[0,0,1]
    v_cvt_pk_bf16_f32 v69, v64, v65
    v_pk_mul_f32 v[70:71], v[52:53], v[50:51] op_sel:[1,1] op_sel_hi:[0,1]
    ds_write_addtid_b32 v69 offset:44384
    v_pk_fma_f32 v[52:53], v[52:53], v[50:51], v[70:71] op_sel_hi:[1,0,1] neg_lo:[0,0,1]
    v_cvt_pk_bf16_f32 v68, v52, v53
    v_pk_mul_f32 v[70:71], v[56:57], v[50:51] op_sel:[1,1] op_sel_hi:[0,1]
    ds_write_addtid_b32 v68 offset:44672
    v_pk_fma_f32 v[56:57], v[56:57], v[50:51], v[70:71] op_sel_hi:[1,0,1] neg_lo:[0,0,1]
    v_cvt_pk_bf16_f32 v69, v56, v57
    v_pk_mul_f32 v[70:71], v[60:61], v[50:51] op_sel:[1,1] op_sel_hi:[0,1]
    ds_write_addtid_b32 v69 offset:44960
    v_pk_fma_f32 v[60:61], v[60:61], v[50:51], v[70:71] op_sel_hi:[1,0,1] neg_lo:[0,0,1]
    v_cvt_pk_bf16_f32 v68, v60, v61
    v_pk_mul_f32 v[70:71], v[64:65], v[50:51] op_sel:[1,1] op_sel_hi:[0,1]
    ds_write_addtid_b32 v68 offset:45248
    v_pk_fma_f32 v[64:65], v[64:65], v[50:51], v[70:71] op_sel_hi:[1,0,1] neg_lo:[0,0,1]
    v_cvt_pk_bf16_f32 v69, v64, v65
    s_waitcnt lgkmcnt(7)
    v_mfma_f32_16x16x32_bf16 v[106:109], v[90:93], v[74:77], 0
    v_mfma_f32_16x16x32_bf16 v[106:109], v[94:97], v[78:81], v[106:109]
    v_mfma_f32_16x16x32_bf16 v[106:109], v[98:101], v[82:85], v[106:109]
    v_mfma_f32_16x16x32_bf16 v[106:109], v[102:105], v[86:89], v[106:109]
    v_pk_mul_f32 v[70:71], v[52:53], v[50:51] op_sel:[1,1] op_sel_hi:[0,1]
    ds_write_addtid_b32 v69 offset:45536
    v_pk_fma_f32 v[52:53], v[52:53], v[50:51], v[70:71] op_sel_hi:[1,0,1] neg_lo:[0,0,1]
    v_cvt_pk_bf16_f32 v68, v52, v53
    v_pk_mul_f32 v[70:71], v[60:61], v[50:51] op_sel:[1,1] op_sel_hi:[0,1]
    ds_write_addtid_b32 v68 offset:45824
    v_pk_fma_f32 v[60:61], v[60:61], v[50:51], v[70:71] op_sel_hi:[1,0,1] neg_lo:[0,0,1]
    v_cvt_pk_bf16_f32 v69, v60, v61
    v_pk_mul_f32 v[70:71], v[52:53], v[50:51] op_sel:[1,1] op_sel_hi:[0,1]
    ds_write_addtid_b32 v69 offset:46112
    v_pk_fma_f32 v[52:53], v[52:53], v[50:51], v[70:71] op_sel_hi:[1,0,1] neg_lo:[0,0,1]
    v_cvt_pk_bf16_f32 v68, v52, v53
    v_pk_mul_f32 v[70:71], v[60:61], v[50:51] op_sel:[1,1] op_sel_hi:[0,1]
    ds_write_addtid_b32 v68 offset:46400
    v_pk_fma_f32 v[60:61], v[60:61], v[50:51], v[70:71] op_sel_hi:[1,0,1] neg_lo:[0,0,1]
    v_cvt_pk_bf16_f32 v69, v60, v61
    v_pk_mul_f32 v[70:71], v[52:53], v[50:51] op_sel:[1,1] op_sel_hi:[0,1]
    ds_write_addtid_b32 v69 offset:46688
    v_pk_fma_f32 v[52:53], v[52:53], v[50:51], v[70:71] op_sel_hi:[1,0,1] neg_lo:[0,0,1]
    v_cvt_pk_bf16_f32 v68, v52, v53
    v_pk_mul_f32 v[70:71], v[60:61], v[50:51] op_sel:[1,1] op_sel_hi:[0,1]
    ds_write_addtid_b32 v68 offset:46976
    v_pk_fma_f32 v[60:61], v[60:61], v[50:51], v[70:71] op_sel_hi:[1,0,1] neg_lo:[0,0,1]
    v_cvt_pk_bf16_f32 v69, v60, v61
    v_pk_mul_f32 v[70:71], v[52:53], v[50:51] op_sel:[1,1] op_sel_hi:[0,1]
    ds_write_addtid_b32 v69 offset:47264
    v_pk_fma_f32 v[52:53], v[52:53], v[50:51], v[70:71] op_sel_hi:[1,0,1] neg_lo:[0,0,1]
    v_cvt_pk_bf16_f32 v68, v52, v53
    v_pk_mul_f32 v[70:71], v[60:61], v[50:51] op_sel:[1,1] op_sel_hi:[0,1]
    ds_write_addtid_b32 v68 offset:47552
    v_pk_fma_f32 v[60:61], v[60:61], v[50:51], v[70:71] op_sel_hi:[1,0,1] neg_lo:[0,0,1]
    v_cvt_pk_bf16_f32 v69, v60, v61
    ds_write_addtid_b32 v69 offset:47840
    ds_read_b128 v[90:93], v32 offset:0
    ds_read_b128 v[94:97], v32 offset:64
    ds_read_b128 v[98:101], v32 offset:128
    ds_read_b128 v[102:105], v32 offset:192
    v_pk_mul_f32 v[70:71], v[52:53], v[50:51] op_sel:[1,1] op_sel_hi:[0,1]
    v_pk_fma_f32 v[52:53], v[52:53], v[50:51], v[70:71] op_sel_hi:[1,0,1] neg_lo:[0,0,1]
    v_cvt_pk_bf16_f32 v68, v52, v53
    v_pk_mul_f32 v[70:71], v[52:53], v[50:51] op_sel:[1,1] op_sel_hi:[0,1]
    ds_write_addtid_b32 v68 offset:43520
    v_pk_fma_f32 v[52:53], v[52:53], v[50:51], v[70:71] op_sel_hi:[1,0,1] neg_lo:[0,0,1]
    v_cvt_pk_bf16_f32 v69, v52, v53
    v_pk_mul_f32 v[70:71], v[52:53], v[50:51] op_sel:[1,1] op_sel_hi:[0,1]
    ds_write_addtid_b32 v69 offset:43808
    v_pk_fma_f32 v[52:53], v[52:53], v[50:51], v[70:71] op_sel_hi:[1,0,1] neg_lo:[0,0,1]
    v_cvt_pk_bf16_f32 v68, v52, v53
    v_pk_mul_f32 v[70:71], v[52:53], v[50:51] op_sel:[1,1] op_sel_hi:[0,1]
    ds_write_addtid_b32 v68 offset:44096
    v_pk_fma_f32 v[52:53], v[52:53], v[50:51], v[70:71] op_sel_hi:[1,0,1] neg_lo:[0,0,1]
    v_cvt_pk_bf16_f32 v69, v52, v53
    v_pk_mul_f32 v[70:71], v[52:53], v[50:51] op_sel:[1,1] op_sel_hi:[0,1]
    ds_write_addtid_b32 v69 offset:44384
    v_pk_fma_f32 v[52:53], v[52:53], v[50:51], v[70:71] op_sel_hi:[1,0,1] neg_lo:[0,0,1]
    v_cvt_pk_bf16_f32 v68, v52, v53
    s_waitcnt lgkmcnt(4)
    v_mfma_f32_16x16x32_bf16 v[110:113], v[90:93], v[74:77], 0
    v_mfma_f32_16x16x32_bf16 v[110:113], v[94:97], v[78:81], v[110:113]
    v_mfma_f32_16x16x32_bf16 v[110:113], v[98:101], v[82:85], v[110:113]
    v_mfma_f32_16x16x32_bf16 v[110:113], v[102:105], v[86:89], v[110:113]
    v_pk_mul_f32 v[70:71], v[52:53], v[50:51] op_sel:[1,1] op_sel_hi:[0,1]
    ds_write_addtid_b32 v68 offset:44672
    v_pk_fma_f32 v[52:53], v[52:53], v[50:51], v[70:71] op_sel_hi:[1,0,1] neg_lo:[0,0,1]
    v_cvt_pk_bf16_f32 v69, v52, v53
    v_pk_mul_f32 v[70:71], v[52:53], v[50:51] op_sel:[1,1] op_sel_hi:[0,1]
    ds_write_addtid_b32 v69 offset:44960
    v_pk_fma_f32 v[52:53], v[52:53], v[50:51], v[70:71] op_sel_hi:[1,0,1] neg_lo:[0,0,1]
    v_cvt_pk_bf16_f32 v68, v52, v53
    v_pk_mul_f32 v[70:71], v[52:53], v[50:51] op_sel:[1,1] op_sel_hi:[0,1]
    ds_write_addtid_b32 v68 offset:45248
    v_pk_fma_f32 v[52:53], v[52:53], v[50:51], v[70:71] op_sel_hi:[1,0,1] neg_lo:[0,0,1]
    v_cvt_pk_bf16_f32 v69, v52, v53
    v_pk_mul_f32 v[70:71], v[52:53], v[50:51] op_sel:[1,1] op_sel_hi:[0,1]
    ds_write_addtid_b32 v69 offset:45536
    v_pk_fma_f32 v[52:53], v[52:53], v[50:51], v[70:71] op_sel_hi:[1,0,1] neg_lo:[0,0,1]
    v_cvt_pk_bf16_f32 v68, v52, v53
    ds_write_addtid_b32 v68 offset:45824
    ds_read_b128 v[90:93], v32 offset:0
    ds_read_b128 v[94:97], v32 offset:64
    ds_read_b128 v[98:101], v32 offset:128
    ds_read_b128 v[102:105], v32 offset:192
    ds_write_b32 v34, v106 offset:0
    ds_write_b32 v34, v107 offset:388
    ds_write_b32 v34, v108 offset:776
    ds_write_b32 v34, v109 offset:1164
    ds_write_b32 v35, v110 offset:0
    ds_write_b32 v35, v111 offset:388
    ds_write_b32 v36, v112 offset:0
    ds_write_b32 v36, v113 offset:388
    s_waitcnt lgkmcnt(8)
    v_mfma_f32_16x16x32_bf16 v[114:117], v[90:93], v[74:77], 0
    v_mfma_f32_16x16x32_bf16 v[114:117], v[94:97], v[78:81], v[114:117]
    v_mfma_f32_16x16x32_bf16 v[114:117], v[98:101], v[82:85], v[114:117]
    v_mfma_f32_16x16x32_bf16 v[114:117], v[102:105], v[86:89], v[114:117]
    v_and_b32 v118, 0xffff, v16
    v_lshrrev_b32 v119, 16, v16
    v_and_b32 v120, 0xffff, v17
    v_lshrrev_b32 v121, 16, v17
    v_and_b32 v122, 0xffff, v18
    v_lshrrev_b32 v123, 16, v18
    v_and_b32 v124, 0xffff, v19
    v_lshrrev_b32 v125, 16, v19
    ds_write_b32 v37, v114 offset:0
    ds_write_b32 v37, v115 offset:8
    ds_write_b32 v37, v116 offset:16
    ds_write_b32 v37, v117 offset:24
    v_lshrrev_b32 v15, 3, v0
    v_and_b32 v21, 7, v0
    v_lshlrev_b32 v25, 14, v15
    v_lshl_add_u32 v25, v21, 4, v25
    v_lshlrev_b32 v24, 4, v0
    v_add_u32 v24, 96768, v24
    s_waitcnt lgkmcnt(0)
    s_barrier
    buffer_load_dwordx4 v[46:49], v25, s[32:35], s60 offen sc1
    buffer_load_dwordx4 v[50:53], v25, s[32:35], s61 offen sc1
    ds_read2st64_b32 v[54:55], v118 offset1:49
    ds_read2st64_b32 v[56:57], v119 offset1:49
    ds_read2st64_b32 v[58:59], v120 offset1:49
    ds_read2st64_b32 v[60:61], v121 offset1:49
    ds_read2st64_b32 v[62:63], v122 offset1:49
    ds_read2st64_b32 v[64:65], v123 offset1:49
    ds_read2st64_b32 v[66:67], v124 offset1:49
    ds_read2st64_b32 v[68:69], v125 offset1:49
    ds_read2st64_b32 v[70:71], v20 offset1:49
    s_mul_i32 s38, s44, 1856
    s_add_u32 s38, s38, 105024
    v_sub_u32 v15, 15, v2
    v_lshrrev_b32 v15, 1, v15
    v_and_b32 v21, 1, v2
    v_mul_u32_u24 v21, 8256, v21
    v_lshlrev_b32 v15, 2, v15
    v_sub_u32 v15, v15, v21
    v_lshl_add_u32 v13, v3, 4, v15
    v_lshl_add_u32 v14, v3, 3, v15
    s_waitcnt lgkmcnt(4)
    v_add_f32 v54, v54, v55
    v_add_f32 v56, v56, v57
    v_add_f32 v58, v58, v59
    v_add_f32 v60, v60, v61
    v_add_f32 v62, v62, v63
    s_waitcnt lgkmcnt(2)
    v_add_f32 v64, v64, v65
    v_add_f32 v66, v66, v67
    s_waitcnt lgkmcnt(0)
    v_add_f32 v68, v68, v69
    v_add_f32 v70, v70, v71
    v_cvt_pk_bf16_f32 v72, v54, v56
    v_cvt_pk_bf16_f32 v76, v56, v58
    v_cvt_pk_bf16_f32 v73, v58, v60
    v_cvt_pk_bf16_f32 v77, v60, v62
    v_cvt_pk_bf16_f32 v74, v62, v64
    v_cvt_pk_bf16_f32 v78, v64, v66
    v_cvt_pk_bf16_f32 v75, v66, v68
    v_cvt_pk_bf16_f32 v79, v68, v70
    ds_write_b128 v24, v[72:75]
    ds_write_b128 v24, v[76:79] offset:8256
    v_add_u32 v11, s38, v13
    v_add_u32 v12, 1024, v11
    v_add_u32 v13, 112448, v13
    s_add_u32 s38, s38, 1088
    v_add_u32 v14, s38, v14
    s_mul_i32 s38, s44, 4640
    s_add_u32 s38, s38, 16384
    v_lshlrev_b32 v10, 5, v2
    v_lshl_add_u32 v10, v3, 4, v10
    v_add_u32 v10, s38, v10
    v_lshrrev_b32 v15, 3, v0
    v_and_b32 v21, 3, v0
    v_lshlrev_b32 v26, 5, v15
    v_mad_u32_u24 v26, v21, s48, v26
    v_bfe_u32 v21, v0, 2, 1
    v_lshl_add_u32 v26, v21, 4, v26
    s_waitcnt vmcnt(1)
    ds_write_b128 v26, v[46:49] offset:16896
    v_not_b32 v16, v46
    s_waitcnt vmcnt(0)
    ds_write_b128 v26, v[50:53] offset:18944
    v_not_b32 v17, v50
    s_waitcnt lgkmcnt(0)
    s_barrier
    s_cmp_ge_u32 s37, 4
    s_cbranch_scc1 L_noconv1_36
    ds_read_b128 v[102:105], v10 offset:464
    ds_read2_b32 v[106:107], v13 offset0:28 offset1:29
    ds_read2_b32 v[108:109], v13 offset0:30 offset1:31
    ds_read_b128 v[110:113], v10 offset:480
    ds_read2_b32 v[114:115], v13 offset0:0 offset1:1
    ds_read2_b32 v[116:117], v13 offset0:2 offset1:3
    ds_read_b128 v[118:121], v10 offset:976
    ds_read_b128 v[122:125], v10 offset:992
    ds_read_b128 v[126:129], v10 offset:1488
    ds_read_b128 v[130:133], v10 offset:1504
    ds_read2_b32 v[134:135], v14 offset0:16 offset1:17
    ds_read2_b32 v[136:137], v14 offset0:40 offset1:41
    s_waitcnt lgkmcnt(9)
    v_mfma_f32_16x16x32_bf16 v[78:81], v[102:105], v[106:109], 0
    ds_read2_b32 v[138:139], v14 offset0:8 offset1:9
    s_waitcnt lgkmcnt(7)
    v_mfma_f32_16x16x32_bf16 v[82:85], v[110:113], v[114:117], 0
    ds_read2_b32 v[140:141], v14 offset0:32 offset1:33
    s_waitcnt lgkmcnt(7)
    v_mfma_f32_16x16x32_bf16 v[86:89], v[118:121], v[106:109], 0
    ds_read2_b32 v[142:143], v14 offset0:0 offset1:1
    ds_read2_b32 v[144:145], v14 offset0:24 offset1:25
    s_waitcnt lgkmcnt(8)
    v_mfma_f32_16x16x32_bf16 v[90:93], v[122:125], v[114:117], 0
    ds_read_b128 v[146:149], v10 offset:2000
    v_cvt_pk_bf16_f32 v94, v78, v79
    v_cvt_pk_bf16_f32 v95, v80, v81
    v_cvt_pk_bf16_f32 v96, v82, v83
    v_cvt_pk_bf16_f32 v97, v84, v85
    s_waitcnt lgkmcnt(8)
    v_mfma_f32_16x16x32_bf16 v[78:81], v[126:129], v[106:109], 0
    ds_read_b128 v[150:153], v10 offset:2016
    s_waitcnt lgkmcnt(8)
    v_mfma_f32_16x16x32_bf16 v[82:85], v[130:133], v[114:117], 0
    ds_read_b128 v[154:157], v10 offset:2512
    v_cvt_pk_bf16_f32 v98, v86, v87
    s_waitcnt lgkmcnt(7)
    v_mfma_f32_16x16x32_bf16 v[54:57], v[94:97], v[134:137], 0
    ds_read_b128 v[158:161], v10 offset:2528
    v_cvt_pk_bf16_f32 v99, v88, v89
    s_waitcnt lgkmcnt(6)
    v_mfma_f32_16x16x32_bf16 v[58:61], v[94:97], v[138:141], 0
    ds_read_b128 v[162:165], v10 offset:3024
    v_cvt_pk_bf16_f32 v100, v90, v91
    s_waitcnt lgkmcnt(5)
    v_mfma_f32_16x16x32_bf16 v[62:65], v[94:97], v[142:145], 0
    ds_read_b128 v[102:105], v10 offset:3040
    v_cvt_pk_bf16_f32 v101, v92, v93
    s_waitcnt lgkmcnt(5)
    v_mfma_f32_16x16x32_bf16 v[86:89], v[146:149], v[106:109], 0
    ds_read2_b32 v[118:119], v13 offset0:4 offset1:5
    s_waitcnt lgkmcnt(5)
    v_mfma_f32_16x16x32_bf16 v[90:93], v[150:153], v[114:117], 0
    ds_read2_b32 v[120:121], v13 offset0:6 offset1:7
    v_cvt_pk_bf16_f32 v94, v78, v79
    v_mfma_f32_16x16x32_bf16 v[58:61], v[98:101], v[134:137], v[58:61]
    ds_read2_b32 v[126:127], v14 offset0:64 offset1:65
    v_cvt_pk_bf16_f32 v95, v80, v81
    v_mfma_f32_16x16x32_bf16 v[62:65], v[98:101], v[138:141], v[62:65]
    ds_read2_b32 v[128:129], v14 offset0:88 offset1:89
    v_cvt_pk_bf16_f32 v96, v82, v83
    v_mfma_f32_16x16x32_bf16 v[66:69], v[98:101], v[142:145], 0
    ds_read2_b32 v[146:147], v14 offset0:56 offset1:57
    v_cvt_pk_bf16_f32 v97, v84, v85
    s_waitcnt lgkmcnt(8)
    v_mfma_f32_16x16x32_bf16 v[78:81], v[154:157], v[106:109], 0
    ds_read2_b32 v[148:149], v14 offset0:80 offset1:81
    s_waitcnt lgkmcnt(8)
    v_mfma_f32_16x16x32_bf16 v[82:85], v[158:161], v[114:117], 0
    ds_read2_b32 v[154:155], v14 offset0:48 offset1:49
    v_cvt_pk_bf16_f32 v98, v86, v87
    v_mfma_f32_16x16x32_bf16 v[62:65], v[94:97], v[134:137], v[62:65]
    ds_read2_b32 v[156:157], v14 offset0:72 offset1:73
    v_cvt_pk_bf16_f32 v99, v88, v89
    v_mfma_f32_16x16x32_bf16 v[66:69], v[94:97], v[138:141], v[66:69]
    v_cvt_pk_bf16_f32 v100, v90, v91
    v_mfma_f32_16x16x32_bf16 v[70:73], v[94:97], v[142:145], 0
    v_cvt_pk_bf16_f32 v101, v92, v93
    s_waitcnt lgkmcnt(9)
    v_mfma_f32_16x16x32_bf16 v[86:89], v[162:165], v[106:109], 0
    ds_read_b128 v[162:165], v10 offset:464
    s_waitcnt lgkmcnt(9)
    v_mfma_f32_16x16x32_bf16 v[90:93], v[102:105], v[114:117], 0
    ds_read2_b32 v[114:115], v13 offset0:52 offset1:53
    v_cvt_pk_bf16_f32 v94, v78, v79
    v_mfma_f32_16x16x32_bf16 v[66:69], v[98:101], v[134:137], v[66:69]
    ds_read2_b32 v[116:117], v13 offset0:54 offset1:55
    v_cvt_pk_bf16_f32 v95, v80, v81
    v_mfma_f32_16x16x32_bf16 v[70:73], v[98:101], v[138:141], v[70:73]
    v_cvt_pk_bf16_f32 v96, v82, v83
    v_mfma_f32_16x16x32_bf16 v[74:77], v[98:101], v[142:145], 0
    ds_read2_b32 v[142:143], v13 offset0:76 offset1:77
    v_cvt_pk_bf16_f32 v97, v84, v85
    v_mfma_f32_16x16x32_bf16 v[78:81], v[110:113], v[106:109], 0
    ds_read2_b32 v[144:145], v13 offset0:78 offset1:79
    v_cvt_pk_bf16_f32 v98, v86, v87
    s_waitcnt lgkmcnt(11)
    v_mfma_f32_16x16x32_bf16 v[82:85], v[110:113], v[118:121], 0
    v_cvt_pk_bf16_f32 v99, v88, v89
    v_mfma_f32_16x16x32_bf16 v[70:73], v[94:97], v[134:137], v[70:73]
    v_cvt_pk_bf16_f32 v100, v90, v91
    v_mfma_f32_16x16x32_bf16 v[74:77], v[94:97], v[138:141], v[74:77]
    ds_read_b128 v[138:141], v10 offset:976
    v_cvt_pk_bf16_f32 v101, v92, v93
    v_mfma_f32_16x16x32_bf16 v[86:89], v[122:125], v[106:109], 0
    v_cvt_pk_bf16_f32 v94, v78, v79
    v_cvt_pk_bf16_f32 v95, v80, v81
    v_mfma_f32_16x16x32_bf16 v[90:93], v[122:125], v[118:121], 0
    v_cvt_pk_bf16_f32 v96, v82, v83
    v_mfma_f32_16x16x32_bf16 v[74:77], v[98:101], v[134:137], v[74:77]
    ds_read_b128 v[134:137], v10 offset:1488
    v_cvt_pk_bf16_f32 v97, v84, v85
    v_mfma_f32_16x16x32_bf16 v[78:81], v[130:133], v[106:109], 0
    v_mfma_f32_16x16x32_bf16 v[82:85], v[130:133], v[118:121], 0
    v_cvt_pk_bf16_f32 v98, v86, v87
    s_waitcnt lgkmcnt(11)
    v_mfma_f32_16x16x32_bf16 v[54:57], v[94:97], v[126:129], v[54:57]
    v_cvt_pk_bf16_f32 v99, v88, v89
    s_waitcnt lgkmcnt(9)
    v_mfma_f32_16x16x32_bf16 v[58:61], v[94:97], v[146:149], v[58:61]
    v_cvt_pk_bf16_f32 v100, v90, v91
    s_waitcnt lgkmcnt(7)
    v_mfma_f32_16x16x32_bf16 v[62:65], v[94:97], v[154:157], v[62:65]
    v_cvt_pk_bf16_f32 v101, v92, v93
    v_mfma_f32_16x16x32_bf16 v[86:89], v[150:153], v[106:109], 0
    v_mfma_f32_16x16x32_bf16 v[90:93], v[150:153], v[118:121], 0
    v_cvt_pk_bf16_f32 v94, v78, v79
    v_mfma_f32_16x16x32_bf16 v[58:61], v[98:101], v[126:129], v[58:61]
    v_cvt_pk_bf16_f32 v95, v80, v81
    v_mfma_f32_16x16x32_bf16 v[62:65], v[98:101], v[146:149], v[62:65]
    v_cvt_pk_bf16_f32 v96, v82, v83
    v_mfma_f32_16x16x32_bf16 v[66:69], v[98:101], v[154:157], v[66:69]
    v_cvt_pk_bf16_f32 v97, v84, v85
    v_mfma_f32_16x16x32_bf16 v[78:81], v[158:161], v[106:109], 0
    v_mfma_f32_16x16x32_bf16 v[82:85], v[158:161], v[118:121], 0
    v_cvt_pk_bf16_f32 v98, v86, v87
    v_mfma_f32_16x16x32_bf16 v[62:65], v[94:97], v[126:129], v[62:65]
    v_cvt_pk_bf16_f32 v99, v88, v89
    v_mfma_f32_16x16x32_bf16 v[66:69], v[94:97], v[146:149], v[66:69]
    v_cvt_pk_bf16_f32 v100, v90, v91
    v_mfma_f32_16x16x32_bf16 v[70:73], v[94:97], v[154:157], v[70:73]
    v_cvt_pk_bf16_f32 v101, v92, v93
    v_mfma_f32_16x16x32_bf16 v[86:89], v[102:105], v[106:109], 0
    ds_read2_b32 v[106:107], v14 offset0:128 offset1:129
    v_mfma_f32_16x16x32_bf16 v[90:93], v[102:105], v[118:121], 0
    ds_read2_b32 v[108:109], v14 offset0:168 offset1:169
    v_cvt_pk_bf16_f32 v94, v78, v79
    v_mfma_f32_16x16x32_bf16 v[66:69], v[98:101], v[126:129], v[66:69]
    ds_read2_b32 v[118:119], v14 offset0:120 offset1:121
    v_cvt_pk_bf16_f32 v95, v80, v81
    v_mfma_f32_16x16x32_bf16 v[70:73], v[98:101], v[146:149], v[70:73]
    ds_read2_b32 v[120:121], v14 offset0:160 offset1:161
    v_cvt_pk_bf16_f32 v96, v82, v83
    v_mfma_f32_16x16x32_bf16 v[74:77], v[98:101], v[154:157], v[74:77]
    ds_read2_b32 v[154:155], v14 offset0:112 offset1:113
    v_cvt_pk_bf16_f32 v97, v84, v85
    s_waitcnt lgkmcnt(9)
    v_mfma_f32_16x16x32_bf16 v[78:81], v[162:165], v[114:117], 0
    ds_read2_b32 v[156:157], v14 offset0:152 offset1:153
    v_cvt_pk_bf16_f32 v98, v86, v87
    s_waitcnt lgkmcnt(8)
    v_mfma_f32_16x16x32_bf16 v[82:85], v[110:113], v[142:145], 0
    ds_read2_b32 v[162:163], v14 offset0:104 offset1:105
    v_cvt_pk_bf16_f32 v99, v88, v89
    v_mfma_f32_16x16x32_bf16 v[70:73], v[94:97], v[126:129], v[70:73]
    ds_read2_b32 v[164:165], v14 offset0:144 offset1:145
    v_cvt_pk_bf16_f32 v100, v90, v91
    v_mfma_f32_16x16x32_bf16 v[74:77], v[94:97], v[146:149], v[74:77]
    ds_read_b128 v[146:149], v10 offset:2000
    v_cvt_pk_bf16_f32 v101, v92, v93
    s_waitcnt lgkmcnt(10)
    v_mfma_f32_16x16x32_bf16 v[86:89], v[138:141], v[114:117], 0
    ds_read2_b32 v[138:139], v12 offset0:0 offset1:1
    v_cvt_pk_bf16_f32 v94, v78, v79
    v_cvt_pk_bf16_f32 v95, v80, v81
    v_mfma_f32_16x16x32_bf16 v[90:93], v[122:125], v[142:145], 0
    ds_read2_b32 v[140:141], v12 offset0:2 offset1:3
    v_cvt_pk_bf16_f32 v96, v82, v83
    v_mfma_f32_16x16x32_bf16 v[74:77], v[98:101], v[126:129], v[74:77]
    ds_read_b128 v[126:129], v10 offset:3552
    v_cvt_pk_bf16_f32 v97, v84, v85
    s_waitcnt lgkmcnt(12)
    v_mfma_f32_16x16x32_bf16 v[78:81], v[134:137], v[114:117], 0
    ds_read_b128 v[134:137], v10 offset:4064
    v_mfma_f32_16x16x32_bf16 v[82:85], v[130:133], v[142:145], 0
    s_waitcnt lgkmcnt(11)
    v_mfma_f32_16x16x32_bf16 v[62:65], v[94:97], v[106:109], v[62:65]
    v_cvt_pk_bf16_f32 v98, v86, v87
    s_waitcnt lgkmcnt(9)
    v_mfma_f32_16x16x32_bf16 v[66:69], v[94:97], v[118:121], v[66:69]
    v_cvt_pk_bf16_f32 v99, v88, v89
    s_waitcnt lgkmcnt(7)
    v_mfma_f32_16x16x32_bf16 v[70:73], v[94:97], v[154:157], v[70:73]
    v_cvt_pk_bf16_f32 v100, v90, v91
    s_waitcnt lgkmcnt(5)
    v_mfma_f32_16x16x32_bf16 v[74:77], v[94:97], v[162:165], v[74:77]
    ds_read2_b32 v[162:163], v11 offset0:128 offset1:129
    v_cvt_pk_bf16_f32 v101, v92, v93
    s_waitcnt lgkmcnt(5)
    v_mfma_f32_16x16x32_bf16 v[86:89], v[146:149], v[114:117], 0
    ds_read2_b32 v[164:165], v11 offset0:130 offset1:131
    v_mfma_f32_16x16x32_bf16 v[90:93], v[150:153], v[142:145], 0
    ds_read2_b32 v[114:115], v11 offset0:0 offset1:1
    v_cvt_pk_bf16_f32 v94, v78, v79
    v_mfma_f32_16x16x32_bf16 v[66:69], v[98:101], v[106:109], v[66:69]
    ds_read2_b32 v[116:117], v11 offset0:2 offset1:3
    v_cvt_pk_bf16_f32 v95, v80, v81
    v_mfma_f32_16x16x32_bf16 v[70:73], v[98:101], v[118:121], v[70:73]
    ds_read2_b32 v[146:147], v12 offset0:192 offset1:193
    v_cvt_pk_bf16_f32 v96, v82, v83
    v_mfma_f32_16x16x32_bf16 v[74:77], v[98:101], v[154:157], v[74:77]
    ds_read2_b32 v[148:149], v12 offset0:194 offset1:195
    v_cvt_pk_bf16_f32 v97, v84, v85
    s_waitcnt lgkmcnt(7)
    v_mfma_f32_16x16x32_bf16 v[70:73], v[138:141], v[126:129], v[70:73]
    ds_read2_b32 v[142:143], v11 offset0:240 offset1:241
    v_cvt_pk_bf16_f32 v98, v86, v87
    v_mfma_f32_16x16x32_bf16 v[62:65], v[138:141], v[158:161], v[62:65]
    ds_read_b128 v[154:157], v10 offset:416
    v_cvt_pk_bf16_f32 v99, v88, v89
    v_mfma_f32_16x16x32_bf16 v[70:73], v[94:97], v[106:109], v[70:73]
    ds_read2_b32 v[144:145], v11 offset0:242 offset1:243
    v_cvt_pk_bf16_f32 v100, v90, v91
    v_mfma_f32_16x16x32_bf16 v[74:77], v[94:97], v[118:121], v[74:77]
    ds_read2_b32 v[118:119], v11 offset0:112 offset1:113
    v_cvt_pk_bf16_f32 v101, v92, v93
    s_waitcnt lgkmcnt(10)
    v_mfma_f32_16x16x32_bf16 v[74:77], v[138:141], v[134:137], v[74:77]
    ds_read2_b32 v[120:121], v11 offset0:114 offset1:115
    v_mfma_f32_16x16x32_bf16 v[66:69], v[138:141], v[102:105], v[66:69]
    ds_read_b128 v[134:137], v10 offset:928
    v_mfma_f32_16x16x32_bf16 v[74:77], v[98:101], v[106:109], v[74:77]
    ds_read_b128 v[106:109], v10 offset:1440
    v_mfma_f32_16x16x32_bf16 v[46:49], v[138:141], v[110:113], 0
    s_waitcnt lgkmcnt(11)
    v_mfma_f32_16x16x32_bf16 v[50:53], v[162:165], v[110:113], 0
    s_waitcnt lgkmcnt(9)
    v_mfma_f32_16x16x32_bf16 v[54:57], v[114:117], v[110:113], v[54:57]
    s_waitcnt lgkmcnt(7)
    v_mfma_f32_16x16x32_bf16 v[62:65], v[146:149], v[110:113], v[62:65]
    ds_read_b128 v[110:113], v10 offset:1952
    v_mfma_f32_16x16x32_bf16 v[50:53], v[138:141], v[122:125], v[50:53]
    v_mfma_f32_16x16x32_bf16 v[54:57], v[162:165], v[122:125], v[54:57]
    v_mfma_f32_16x16x32_bf16 v[58:61], v[114:117], v[122:125], v[58:61]
    v_mfma_f32_16x16x32_bf16 v[66:69], v[146:149], v[122:125], v[66:69]
    ds_read_b128 v[122:125], v10 offset:2464
    v_mfma_f32_16x16x32_bf16 v[54:57], v[138:141], v[130:133], v[54:57]
    v_mfma_f32_16x16x32_bf16 v[58:61], v[162:165], v[130:133], v[58:61]
    v_mfma_f32_16x16x32_bf16 v[62:65], v[114:117], v[130:133], v[62:65]
    v_mfma_f32_16x16x32_bf16 v[70:73], v[146:149], v[130:133], v[70:73]
    ds_read_b128 v[130:133], v10 offset:2976
    v_mfma_f32_16x16x32_bf16 v[58:61], v[138:141], v[150:153], v[58:61]
    ds_read_b128 v[138:141], v10 offset:3488
    v_mfma_f32_16x16x32_bf16 v[62:65], v[162:165], v[150:153], v[62:65]
    v_mfma_f32_16x16x32_bf16 v[66:69], v[114:117], v[150:153], v[66:69]
    v_mfma_f32_16x16x32_bf16 v[74:77], v[146:149], v[150:153], v[74:77]
    ds_read_b128 v[146:149], v10 offset:4000
    v_mfma_f32_16x16x32_bf16 v[66:69], v[162:165], v[158:161], v[66:69]
    ds_read2_b32 v[150:151], v11 offset0:224 offset1:225
    v_mfma_f32_16x16x32_bf16 v[70:73], v[114:117], v[158:161], v[70:73]
    ds_read_b128 v[158:161], v10 offset:352
    v_mfma_f32_16x16x32_bf16 v[70:73], v[162:165], v[102:105], v[70:73]
    s_waitcnt lgkmcnt(9)
    ds_read2_b32 v[152:153], v11 offset0:226 offset1:227
    v_mfma_f32_16x16x32_bf16 v[74:77], v[114:117], v[102:105], v[74:77]
    ds_read2_b32 v[102:103], v11 offset0:96 offset1:97
    v_mfma_f32_16x16x32_bf16 v[74:77], v[162:165], v[126:129], v[74:77]
    ds_read2_b32 v[104:105], v11 offset0:98 offset1:99
    v_mfma_f32_16x16x32_bf16 v[46:49], v[142:145], v[154:157], v[46:49]
    ds_read_b128 v[114:117], v10 offset:864
    v_mfma_f32_16x16x32_bf16 v[50:53], v[118:121], v[154:157], v[50:53]
    ds_read_b128 v[126:129], v10 offset:1376
    s_waitcnt lgkmcnt(13)
    v_mfma_f32_16x16x32_bf16 v[50:53], v[142:145], v[134:137], v[50:53]
    ds_read_b128 v[162:165], v10 offset:1888
    v_mfma_f32_16x16x32_bf16 v[54:57], v[118:121], v[134:137], v[54:57]
    s_waitcnt lgkmcnt(9)
    ds_read_b128 v[154:157], v10 offset:2400
    v_mfma_f32_16x16x32_bf16 v[54:57], v[142:145], v[106:109], v[54:57]
    ds_read_b128 v[134:137], v10 offset:2912
    v_mfma_f32_16x16x32_bf16 v[58:61], v[118:121], v[106:109], v[58:61]
    ds_read_b128 v[106:109], v10 offset:3424
    v_mfma_f32_16x16x32_bf16 v[58:61], v[142:145], v[110:113], v[58:61]
    v_mfma_f32_16x16x32_bf16 v[62:65], v[118:121], v[110:113], v[62:65]
    ds_read_b128 v[110:113], v10 offset:3936
    v_mfma_f32_16x16x32_bf16 v[62:65], v[142:145], v[122:125], v[62:65]
    v_mfma_f32_16x16x32_bf16 v[66:69], v[118:121], v[122:125], v[66:69]
    ds_read2_b32 v[122:123], v11 offset0:208 offset1:209
    v_mfma_f32_16x16x32_bf16 v[66:69], v[142:145], v[130:133], v[66:69]
    s_waitcnt lgkmcnt(9)
    ds_read2_b32 v[124:125], v11 offset0:210 offset1:211
    v_mfma_f32_16x16x32_bf16 v[70:73], v[118:121], v[130:133], v[70:73]
    ds_read_b128 v[130:133], v10 offset:288
    v_mfma_f32_16x16x32_bf16 v[70:73], v[142:145], v[138:141], v[70:73]
    v_mfma_f32_16x16x32_bf16 v[74:77], v[118:121], v[138:141], v[74:77]
    ds_read2_b32 v[118:119], v11 offset0:80 offset1:81
    v_mfma_f32_16x16x32_bf16 v[74:77], v[142:145], v[146:149], v[74:77]
    ds_read2_b32 v[120:121], v11 offset0:82 offset1:83
    v_mfma_f32_16x16x32_bf16 v[46:49], v[150:153], v[158:161], v[46:49]
    ds_read_b128 v[138:141], v10 offset:800
    s_waitcnt lgkmcnt(13)
    v_mfma_f32_16x16x32_bf16 v[50:53], v[102:105], v[158:161], v[50:53]
    ds_read_b128 v[142:145], v10 offset:1312
    s_waitcnt lgkmcnt(13)
    v_mfma_f32_16x16x32_bf16 v[50:53], v[150:153], v[114:117], v[50:53]
    ds_read_b128 v[146:149], v10 offset:1824
    v_mfma_f32_16x16x32_bf16 v[54:57], v[102:105], v[114:117], v[54:57]
    s_waitcnt lgkmcnt(9)
    ds_read_b128 v[158:161], v10 offset:2336
    v_mfma_f32_16x16x32_bf16 v[54:57], v[150:153], v[126:129], v[54:57]
    ds_read_b128 v[114:117], v10 offset:2848
    v_mfma_f32_16x16x32_bf16 v[58:61], v[102:105], v[126:129], v[58:61]
    ds_read_b128 v[126:129], v10 offset:3360
    v_mfma_f32_16x16x32_bf16 v[58:61], v[150:153], v[162:165], v[58:61]
    v_mfma_f32_16x16x32_bf16 v[62:65], v[102:105], v[162:165], v[62:65]
    ds_read_b128 v[162:165], v10 offset:3872
    v_mfma_f32_16x16x32_bf16 v[62:65], v[150:153], v[154:157], v[62:65]
    v_mfma_f32_16x16x32_bf16 v[66:69], v[102:105], v[154:157], v[66:69]
    ds_read2_b32 v[154:155], v11 offset0:192 offset1:193
    v_mfma_f32_16x16x32_bf16 v[66:69], v[150:153], v[134:137], v[66:69]
    s_waitcnt lgkmcnt(9)
    ds_read2_b32 v[156:157], v11 offset0:194 offset1:195
    v_mfma_f32_16x16x32_bf16 v[70:73], v[102:105], v[134:137], v[70:73]
    ds_read_b128 v[134:137], v10 offset:224
    v_mfma_f32_16x16x32_bf16 v[70:73], v[150:153], v[106:109], v[70:73]
    v_mfma_f32_16x16x32_bf16 v[74:77], v[102:105], v[106:109], v[74:77]
    ds_read2_b32 v[102:103], v11 offset0:64 offset1:65
    v_mfma_f32_16x16x32_bf16 v[74:77], v[150:153], v[110:113], v[74:77]
    ds_read2_b32 v[104:105], v11 offset0:66 offset1:67
    v_mfma_f32_16x16x32_bf16 v[46:49], v[122:125], v[130:133], v[46:49]
    ds_read_b128 v[106:109], v10 offset:736
    s_waitcnt lgkmcnt(13)
    v_mfma_f32_16x16x32_bf16 v[50:53], v[118:121], v[130:133], v[50:53]
    ds_read_b128 v[110:113], v10 offset:1248
    s_waitcnt lgkmcnt(13)
    v_mfma_f32_16x16x32_bf16 v[50:53], v[122:125], v[138:141], v[50:53]
    ds_read_b128 v[150:153], v10 offset:1760
    v_mfma_f32_16x16x32_bf16 v[54:57], v[118:121], v[138:141], v[54:57]
    s_waitcnt lgkmcnt(9)
    ds_read_b128 v[130:133], v10 offset:2272
    v_mfma_f32_16x16x32_bf16 v[54:57], v[122:125], v[142:145], v[54:57]
    ds_read_b128 v[138:141], v10 offset:2784
    v_mfma_f32_16x16x32_bf16 v[58:61], v[118:121], v[142:145], v[58:61]
    ds_read_b128 v[142:145], v10 offset:3296
    v_mfma_f32_16x16x32_bf16 v[58:61], v[122:125], v[146:149], v[58:61]
    v_mfma_f32_16x16x32_bf16 v[62:65], v[118:121], v[146:149], v[62:65]
    ds_read_b128 v[146:149], v10 offset:3808
    v_mfma_f32_16x16x32_bf16 v[62:65], v[122:125], v[158:161], v[62:65]
    v_mfma_f32_16x16x32_bf16 v[66:69], v[118:121], v[158:161], v[66:69]
    ds_read2_b32 v[158:159], v11 offset0:176 offset1:177
    v_mfma_f32_16x16x32_bf16 v[66:69], v[122:125], v[114:117], v[66:69]
    s_waitcnt lgkmcnt(9)
    ds_read2_b32 v[160:161], v11 offset0:178 offset1:179
    v_mfma_f32_16x16x32_bf16 v[70:73], v[118:121], v[114:117], v[70:73]
    ds_read_b128 v[114:117], v10 offset:160
    v_mfma_f32_16x16x32_bf16 v[70:73], v[122:125], v[126:129], v[70:73]
    v_mfma_f32_16x16x32_bf16 v[74:77], v[118:121], v[126:129], v[74:77]
    ds_read2_b32 v[118:119], v11 offset0:48 offset1:49
    v_mfma_f32_16x16x32_bf16 v[74:77], v[122:125], v[162:165], v[74:77]
    ds_read2_b32 v[120:121], v11 offset0:50 offset1:51
    v_mfma_f32_16x16x32_bf16 v[46:49], v[154:157], v[134:137], v[46:49]
    ds_read_b128 v[126:129], v10 offset:672
    s_waitcnt lgkmcnt(13)
    v_mfma_f32_16x16x32_bf16 v[50:53], v[102:105], v[134:137], v[50:53]
    ds_read_b128 v[122:125], v10 offset:1184
    s_waitcnt lgkmcnt(13)
    v_mfma_f32_16x16x32_bf16 v[50:53], v[154:157], v[106:109], v[50:53]
    ds_read_b128 v[162:165], v10 offset:1696
    v_mfma_f32_16x16x32_bf16 v[54:57], v[102:105], v[106:109], v[54:57]
    s_waitcnt lgkmcnt(9)
    ds_read_b128 v[134:137], v10 offset:2208
    v_mfma_f32_16x16x32_bf16 v[54:57], v[154:157], v[110:113], v[54:57]
    ds_read_b128 v[106:109], v10 offset:2720
    v_mfma_f32_16x16x32_bf16 v[58:61], v[102:105], v[110:113], v[58:61]
    ds_read_b128 v[110:113], v10 offset:3232
    v_mfma_f32_16x16x32_bf16 v[58:61], v[154:157], v[150:153], v[58:61]
    v_mfma_f32_16x16x32_bf16 v[62:65], v[102:105], v[150:153], v[62:65]
    ds_read_b128 v[150:153], v10 offset:3744
    v_mfma_f32_16x16x32_bf16 v[62:65], v[154:157], v[130:133], v[62:65]
    v_mfma_f32_16x16x32_bf16 v[66:69], v[102:105], v[130:133], v[66:69]
    ds_read2_b32 v[130:131], v11 offset0:160 offset1:161
    v_mfma_f32_16x16x32_bf16 v[66:69], v[154:157], v[138:141], v[66:69]
    s_waitcnt lgkmcnt(9)
    ds_read2_b32 v[132:133], v11 offset0:162 offset1:163
    v_mfma_f32_16x16x32_bf16 v[70:73], v[102:105], v[138:141], v[70:73]
    ds_read_b128 v[138:141], v10 offset:96
    v_mfma_f32_16x16x32_bf16 v[70:73], v[154:157], v[142:145], v[70:73]
    v_mfma_f32_16x16x32_bf16 v[74:77], v[102:105], v[142:145], v[74:77]
    ds_read2_b32 v[102:103], v11 offset0:32 offset1:33
    v_mfma_f32_16x16x32_bf16 v[74:77], v[154:157], v[146:149], v[74:77]
    ds_read2_b32 v[104:105], v11 offset0:34 offset1:35
    v_mfma_f32_16x16x32_bf16 v[46:49], v[158:161], v[114:117], v[46:49]
    ds_read_b128 v[142:145], v10 offset:608
    s_waitcnt lgkmcnt(13)
    v_mfma_f32_16x16x32_bf16 v[50:53], v[118:121], v[114:117], v[50:53]
    ds_read_b128 v[146:149], v10 offset:1120
    s_waitcnt lgkmcnt(13)
    v_mfma_f32_16x16x32_bf16 v[50:53], v[158:161], v[126:129], v[50:53]
    ds_read_b128 v[154:157], v10 offset:1632
    v_mfma_f32_16x16x32_bf16 v[54:57], v[118:121], v[126:129], v[54:57]
    s_waitcnt lgkmcnt(9)
    ds_read_b128 v[114:117], v10 offset:2144
    v_mfma_f32_16x16x32_bf16 v[54:57], v[158:161], v[122:125], v[54:57]
    ds_read_b128 v[126:129], v10 offset:2656
    v_mfma_f32_16x16x32_bf16 v[58:61], v[118:121], v[122:125], v[58:61]
    ds_read_b128 v[122:125], v10 offset:3168
    v_mfma_f32_16x16x32_bf16 v[58:61], v[158:161], v[162:165], v[58:61]
    v_mfma_f32_16x16x32_bf16 v[62:65], v[118:121], v[162:165], v[62:65]
    ds_read_b128 v[162:165], v10 offset:3680
    v_mfma_f32_16x16x32_bf16 v[62:65], v[158:161], v[134:137], v[62:65]
    v_mfma_f32_16x16x32_bf16 v[66:69], v[118:121], v[134:137], v[66:69]
    ds_read2_b32 v[134:135], v11 offset0:144 offset1:145
    v_mfma_f32_16x16x32_bf16 v[66:69], v[158:161], v[106:109], v[66:69]
    s_waitcnt lgkmcnt(9)
    ds_read2_b32 v[136:137], v11 offset0:146 offset1:147
    v_mfma_f32_16x16x32_bf16 v[70:73], v[118:121], v[106:109], v[70:73]
    ds_read_b128 v[106:109], v10 offset:32
    v_mfma_f32_16x16x32_bf16 v[70:73], v[158:161], v[110:113], v[70:73]
    v_mfma_f32_16x16x32_bf16 v[74:77], v[118:121], v[110:113], v[74:77]
    ds_read2_b32 v[110:111], v11 offset0:16 offset1:17
    v_mfma_f32_16x16x32_bf16 v[74:77], v[158:161], v[150:153], v[74:77]
    ds_read2_b32 v[112:113], v11 offset0:18 offset1:19
    v_mfma_f32_16x16x32_bf16 v[46:49], v[130:133], v[138:141], v[46:49]
    ds_read_b128 v[118:121], v10 offset:544
    s_waitcnt lgkmcnt(13)
    v_mfma_f32_16x16x32_bf16 v[50:53], v[102:105], v[138:141], v[50:53]
    ds_read_b128 v[150:153], v10 offset:1056
    s_waitcnt lgkmcnt(13)
    v_mfma_f32_16x16x32_bf16 v[50:53], v[130:133], v[142:145], v[50:53]
    ds_read_b128 v[158:161], v10 offset:1568
    v_mfma_f32_16x16x32_bf16 v[54:57], v[102:105], v[142:145], v[54:57]
    s_waitcnt lgkmcnt(9)
    ds_read_b128 v[138:141], v10 offset:2080
    v_mfma_f32_16x16x32_bf16 v[54:57], v[130:133], v[146:149], v[54:57]
    ds_read_b128 v[142:145], v10 offset:2592
    v_mfma_f32_16x16x32_bf16 v[58:61], v[102:105], v[146:149], v[58:61]
    ds_read_b128 v[146:149], v10 offset:3104
    v_mfma_f32_16x16x32_bf16 v[58:61], v[130:133], v[154:157], v[58:61]
    v_mfma_f32_16x16x32_bf16 v[62:65], v[102:105], v[154:157], v[62:65]
    ds_read_b128 v[154:157], v10 offset:3616
    v_mfma_f32_16x16x32_bf16 v[62:65], v[130:133], v[114:117], v[62:65]
    v_mfma_f32_16x16x32_bf16 v[66:69], v[102:105], v[114:117], v[66:69]
    v_mfma_f32_16x16x32_bf16 v[66:69], v[130:133], v[126:129], v[66:69]
    v_mfma_f32_16x16x32_bf16 v[70:73], v[102:105], v[126:129], v[70:73]
    v_mfma_f32_16x16x32_bf16 v[70:73], v[130:133], v[122:125], v[70:73]
    v_mfma_f32_16x16x32_bf16 v[74:77], v[102:105], v[122:125], v[74:77]
    s_waitcnt lgkmcnt(12)
    v_mfma_f32_16x16x32_bf16 v[74:77], v[130:133], v[162:165], v[74:77]
    s_waitcnt lgkmcnt(9)
    v_mfma_f32_16x16x32_bf16 v[46:49], v[134:137], v[106:109], v[46:49]
    s_waitcnt lgkmcnt(7)
    v_mfma_f32_16x16x32_bf16 v[50:53], v[110:113], v[106:109], v[50:53]
    s_waitcnt lgkmcnt(6)
    v_mfma_f32_16x16x32_bf16 v[50:53], v[134:137], v[118:121], v[50:53]
    v_mfma_f32_16x16x32_bf16 v[54:57], v[110:113], v[118:121], v[54:57]
    s_waitcnt lgkmcnt(5)
    v_mfma_f32_16x16x32_bf16 v[54:57], v[134:137], v[150:153], v[54:57]
    v_mfma_f32_16x16x32_bf16 v[58:61], v[110:113], v[150:153], v[58:61]
    s_waitcnt lgkmcnt(4)
    v_mfma_f32_16x16x32_bf16 v[58:61], v[134:137], v[158:161], v[58:61]
    v_mfma_f32_16x16x32_bf16 v[62:65], v[110:113], v[158:161], v[62:65]
    s_waitcnt lgkmcnt(3)
    v_mfma_f32_16x16x32_bf16 v[62:65], v[134:137], v[138:141], v[62:65]
    v_mfma_f32_16x16x32_bf16 v[66:69], v[110:113], v[138:141], v[66:69]
    s_waitcnt lgkmcnt(2)
    v_mfma_f32_16x16x32_bf16 v[66:69], v[134:137], v[142:145], v[66:69]
    v_mfma_f32_16x16x32_bf16 v[70:73], v[110:113], v[142:145], v[70:73]
    s_waitcnt lgkmcnt(1)
    v_mfma_f32_16x16x32_bf16 v[70:73], v[134:137], v[146:149], v[70:73]
    v_mfma_f32_16x16x32_bf16 v[74:77], v[110:113], v[146:149], v[74:77]
    s_waitcnt lgkmcnt(0)
    v_mfma_f32_16x16x32_bf16 v[74:77], v[134:137], v[154:157], v[74:77]
    v_lshl_add_u32 v15, v23, 2, s37
    v_and_b32 v21, 7, v2
    v_xor_b32 v15, v15, v21
    v_lshlrev_b32 v9, 4, v15
    v_lshl_add_u32 v9, v22, 3, v9
    v_lshl_add_u32 v9, v2, 7, v9
    v_cvt_pk_bf16_f32 v78, v46, v47
    v_cvt_pk_bf16_f32 v79, v48, v49
    ds_write_b64 v9, v[78:79] offset:0
    v_cvt_pk_bf16_f32 v80, v50, v51
    v_cvt_pk_bf16_f32 v81, v52, v53
    ds_write_b64 v9, v[80:81] offset:2048
    v_cvt_pk_bf16_f32 v82, v54, v55
    v_cvt_pk_bf16_f32 v83, v56, v57
    ds_write_b64 v9, v[82:83] offset:4096
    v_cvt_pk_bf16_f32 v84, v58, v59
    v_cvt_pk_bf16_f32 v85, v60, v61
    ds_write_b64 v9, v[84:85] offset:6144
    v_cvt_pk_bf16_f32 v86, v62, v63
    v_cvt_pk_bf16_f32 v87, v64, v65
    ds_write_b64 v9, v[86:87] offset:8192
    v_cvt_pk_bf16_f32 v88, v66, v67
    v_cvt_pk_bf16_f32 v89, v68, v69
    ds_write_b64 v9, v[88:89] offset:10240
    v_cvt_pk_bf16_f32 v90, v70, v71
    v_cvt_pk_bf16_f32 v91, v72, v73
    ds_write_b64 v9, v[90:91] offset:12288
    v_cvt_pk_bf16_f32 v92, v74, v75
    v_cvt_pk_bf16_f32 v93, v76, v77
    ds_write_b64 v9, v[92:93] offset:14336
L_noconv1_36:
    v_lshrrev_b32 v15, 3, v0
    v_and_b32 v21, 7, v0
    v_and_b32 v8, 7, v15
    v_xor_b32 v8, v8, v21
    v_lshlrev_b32 v8, 4, v8
    v_lshl_add_u32 v8, v15, 7, v8
    s_waitcnt lgkmcnt(0)
    s_barrier
    ds_read_b128 v[102:105], v8 offset:0
    ds_read_b128 v[106:109], v8 offset:8192
    s_waitcnt lgkmcnt(1)
    v_bfi_b32 v102, 1, v16, v102
    buffer_store_dwordx4 v[102:105], v25, s[32:35], s60 offen sc1
    s_waitcnt lgkmcnt(0)
    v_bfi_b32 v106, 1, v17, v106
    buffer_store_dwordx4 v[106:109], v25, s[32:35], s61 offen sc1
    v_lshlrev_b32 v4, 16, v4
    v_lshlrev_b32 v46, 16, v38
    v_and_b32 v47, 0xffff0000, v38
    v_mul_f32 v46, v4, v46
    v_mul_f32 v47, v4, v47
    v_cvt_pk_bf16_f32 v47, v46, v47
    v_lshlrev_b32 v46, 16, v47
    v_and_b32 v47, 0xffff0000, v47
    v_lshlrev_b32 v48, 16, v39
    v_and_b32 v49, 0xffff0000, v39
    v_mul_f32 v48, v4, v48
    v_mul_f32 v49, v4, v49
    v_cvt_pk_bf16_f32 v49, v48, v49
    v_lshlrev_b32 v48, 16, v49
    v_and_b32 v49, 0xffff0000, v49
    v_lshlrev_b32 v50, 16, v40
    v_and_b32 v51, 0xffff0000, v40
    v_mul_f32 v50, v4, v50
    v_mul_f32 v51, v4, v51
    v_cvt_pk_bf16_f32 v51, v50, v51
    v_lshlrev_b32 v50, 16, v51
    v_and_b32 v51, 0xffff0000, v51
    v_lshlrev_b32 v52, 16, v41
    v_and_b32 v53, 0xffff0000, v41
    v_mul_f32 v52, v4, v52
    v_mul_f32 v53, v4, v53
    v_cvt_pk_bf16_f32 v53, v52, v53
    v_lshlrev_b32 v52, 16, v53
    v_and_b32 v53, 0xffff0000, v53
    v_lshlrev_b32 v5, 16, v5
    v_lshlrev_b32 v54, 16, v42
    v_and_b32 v55, 0xffff0000, v42
    v_mul_f32 v54, v5, v54
    v_mul_f32 v55, v5, v55
    v_cvt_pk_bf16_f32 v55, v54, v55
    v_lshlrev_b32 v54, 16, v55
    v_and_b32 v55, 0xffff0000, v55
    v_lshlrev_b32 v56, 16, v43
    v_and_b32 v57, 0xffff0000, v43
    v_mul_f32 v56, v5, v56
    v_mul_f32 v57, v5, v57
    v_cvt_pk_bf16_f32 v57, v56, v57
    v_lshlrev_b32 v56, 16, v57
    v_and_b32 v57, 0xffff0000, v57
    v_lshlrev_b32 v58, 16, v44
    v_and_b32 v59, 0xffff0000, v44
    v_mul_f32 v58, v5, v58
    v_mul_f32 v59, v5, v59
    v_cvt_pk_bf16_f32 v59, v58, v59
    v_lshlrev_b32 v58, 16, v59
    v_and_b32 v59, 0xffff0000, v59
    v_lshlrev_b32 v60, 16, v45
    v_and_b32 v61, 0xffff0000, v45
    v_mul_f32 v60, v5, v60
    v_mul_f32 v61, v5, v61
    v_cvt_pk_bf16_f32 v61, v60, v61
    v_lshlrev_b32 v60, 16, v61
    v_and_b32 v61, 0xffff0000, v61
    s_mul_i32 s38, s37, 3072
    v_lshl_add_u32 v15, v23, 4, v2
    v_mul_u32_u24 v18, 48, v15
    v_lshl_add_u32 v18, v22, 4, v18
    v_add_u32 v18, s38, v18
    v_lshl_add_u32 v15, v3, 3, v27
    v_mul_u32_u24 v19, 48, v15
    v_lshl_add_u32 v19, v28, 3, v19
    v_add_u32 v19, s38, v19
    s_lshl_b32 s38, s36, 15
    s_lshl_b32 s39, s37, 7
    s_add_u32 s38, s38, s39
    v_lshlrev_b32 v20, 11, v2
    v_lshl_add_u32 v20, v3, 4, v20
    v_add_u32 v20, s38, v20
    s_waitcnt vmcnt(0)
    s_sleep 2
    s_mov_b32 s38, 0
L_poll_38:
    buffer_load_dwordx4 v[110:113], v31, s[32:35], s46 offen sc1
    buffer_load_dwordx4 v[114:117], v31, s[32:35], s46 offen offset:1024 sc1
    s_add_u32 s38, s38, 1
    s_waitcnt vmcnt(0)
    v_xor_b32 v24, v110, v38
    v_xor_b32 v26, v114, v42
    v_and_b32 v24, v24, v26
    v_and_b32 v24, 1, v24
    v_cmp_eq_u32 vcc, 0, v24
    s_nop 0
    s_cbranch_vccz L_polled_39
    s_mov_b64 exec, vcc
    s_cmp_lt_u32 s38, 400000
    s_cbranch_scc1 L_poll_38
L_polled_39:
    s_mov_b64 exec, -1
    v_lshlrev_b32 v15, 16, v110
    v_and_b32 v21, 0xffff0000, v110
    v_add_f32 v15, v15, v46
    v_add_f32 v21, v21, v47
    v_cvt_pk_bf16_f32 v110, v15, v21
    v_lshlrev_b32 v15, 16, v111
    v_and_b32 v21, 0xffff0000, v111
    v_add_f32 v15, v15, v48
    v_add_f32 v21, v21, v49
    v_cvt_pk_bf16_f32 v111, v15, v21
    v_lshlrev_b32 v15, 16, v112
    v_and_b32 v21, 0xffff0000, v112
    v_add_f32 v15, v15, v50
    v_add_f32 v21, v21, v51
    v_cvt_pk_bf16_f32 v112, v15, v21
    v_lshlrev_b32 v15, 16, v113
    v_and_b32 v21, 0xffff0000, v113
    v_add_f32 v15, v15, v52
    v_add_f32 v21, v21, v53
    v_cvt_pk_bf16_f32 v113, v15, v21
    ds_write_b128 v18, v[110:113] offset:34944
    v_lshlrev_b32 v15, 16, v114
    v_and_b32 v21, 0xffff0000, v114
    v_add_f32 v15, v15, v54
    v_add_f32 v21, v21, v55
    v_cvt_pk_bf16_f32 v114, v15, v21
    v_lshlrev_b32 v15, 16, v115
    v_and_b32 v21, 0xffff0000, v115
    v_add_f32 v15, v15, v56
    v_add_f32 v21, v21, v57
    v_cvt_pk_bf16_f32 v115, v15, v21
    v_lshlrev_b32 v15, 16, v116
    v_and_b32 v21, 0xffff0000, v116
    v_add_f32 v15, v15, v58
    v_add_f32 v21, v21, v59
    v_cvt_pk_bf16_f32 v116, v15, v21
    v_lshlrev_b32 v15, 16, v117
    v_and_b32 v21, 0xffff0000, v117
    v_add_f32 v15, v15, v60
    v_add_f32 v21, v21, v61
    v_cvt_pk_bf16_f32 v117, v15, v21
    ds_write_b128 v18, v[114:117] offset:36480
    ds_read_b64_tr_b16 v[102:103], v19 offset:34944
    ds_read_b64_tr_b16 v[104:105], v19 offset:35136
    ds_read_b64_tr_b16 v[106:107], v19 offset:36480
    ds_read_b64_tr_b16 v[108:109], v19 offset:36672
    s_waitcnt lgkmcnt(2)
    global_store_dwordx4 v20, v[102:105], s[28:29] offset:0 sc1
    s_waitcnt lgkmcnt(0)
    global_store_dwordx4 v20, v[106:109], s[28:29] offset:64 sc1
    s_branch L_fin
L_ahelp_35:
    v_lshlrev_b32 v8, 10, v1
    s_waitcnt vmcnt(0)
    s_lshl_b32 s38, s36, 10
    s_add_u32 s38, s38, 4325376
    v_lshlrev_b32 v9, 4, v1
    v_mov_b32 v10, v6
    v_mov_b32 v11, v6
    v_mov_b32 v12, v6
    v_mov_b32 v13, v6
    buffer_store_dwordx4 v[10:13], v9, s[32:35], s38 offen sc1
    s_barrier
    s_waitcnt vmcnt(0)
    v_add_u32 v6, 1, v6
    s_barrier
    s_lshl_b32 s38, s36, 10
    s_add_u32 s38, s38, 4325376
    v_lshlrev_b32 v9, 4, v1
    v_mov_b32 v10, v6
    v_mov_b32 v11, v6
    v_mov_b32 v12, v6
    v_mov_b32 v13, v6
    buffer_store_dwordx4 v[10:13], v9, s[32:35], s38 offen sc1
    s_lshr_b32 s39, s36, 4
    s_lshl_b32 s39, s39, 7
    s_add_u32 s39, s39, 4325376
    s_add_u32 s40, s39, 0x10000
    s_mov_b32 s38, 0
    s_sleep 6
L_fpoll_40:
    buffer_load_dword v4, v8, s[32:35], s39 offen sc1
    buffer_load_dword v5, v8, s[32:35], s40 offen sc1
    s_add_u32 s38, s38, 1
    s_waitcnt vmcnt(0)
    v_xor_b32 v4, v4, v6
    v_xor_b32 v5, v5, v6
    v_or_b32 v4, v4, v5
    v_cmp_ne_u32 vcc, 0, v4
    s_nop 0
    s_cbranch_vccz L_fpolled_41
    s_mov_b64 exec, vcc
    s_cmp_lt_u32 s38, 400000
    s_cbranch_scc1 L_fpoll_40
L_fpolled_41:
    s_mov_b64 exec, -1
    s_barrier
    s_cmp_lg_u32 s36, 0
    s_cbranch_scc1 L_noepoch_42
    v_mov_b32 v9, 4456576
    s_mov_b64 exec, 1
    buffer_store_dword v6, v9, s[32:35], 0 offen sc1
    s_mov_b64 exec, -1
L_noepoch_42:
    s_barrier
    s_barrier
L_fin:
L_end:
    s_endpgm
.p2align 6
L_tab:
.long 0x8a008a00, 0x8a008a00, 0x8a008a00, 0x8a008a00, 0x8a008a00, 0x8a008a00, 0x8a008a00, 0x8a008a00
.long 0x8a008a00, 0x8dcc8dcc, 0x8c488dcc, 0x8c488c48, 0x8c488c48, 0x8ac48ac4, 0x89408ac4, 0x89408940
.long 0x93d88940, 0x92549254, 0x90d09254, 0x8f4c8f4c, 0x8dc88f4c, 0x8c448c44, 0x8ac08c44, 0x893c893c
.long 0x93d4893c, 0x92509250, 0x90cc9250, 0x8f488f48, 0x8dc48f48, 0x8c408c40, 0x8abc8c40, 0x89388938
.long 0x93d08938, 0x924c924c, 0x90c8924c, 0x8f448f44, 0x8dc08f44, 0x8c3c8c3c, 0x8ab88c3c, 0x89348934
.long 0x93cc8934, 0x92489248, 0x90c49248, 0x8f408f40, 0x8dbc8f40, 0x8c388c38, 0x8ab48c38, 0x89308930
.long 0x93c88930, 0x92449244, 0x90c09244, 0x8f3c8f3c, 0x8db88f3c, 0x8c348c34, 0x8ab08c34, 0x892c892c
.long 0x93c4892c, 0x92409240, 0x90bc9240, 0x8f388f38, 0x8db48f38, 0x8c308c30, 0x8aac8c30, 0x89288928
.long 0x93c08928, 0x923c923c, 0x90b8923c, 0x8f348f34, 0x8db08f34, 0x8c2c8c2c, 0x8aa88c2c, 0x89248924
.long 0x93bc8924, 0x92389238, 0x90b49238, 0x8f308f30, 0x8dac8f30, 0x8c288c28, 0x8aa48c28, 0x89208920
.long 0x93b88920, 0x92349234, 0x90b09234, 0x8f2c8f2c, 0x8da88f2c, 0x8c248c24, 0x8aa08c24, 0x891c891c
.long 0x93b4891c, 0x92309230, 0x90ac9230, 0x8f288f28, 0x8da48f28, 0x8c208c20, 0x8a9c8c20, 0x89188918
.long 0x93b08918, 0x922c922c, 0x90a8922c, 0x8f248f24, 0x8da08f24, 0x8c1c8c1c, 0x8a988c1c, 0x89148914
.long 0x93ac8914, 0x92289228, 0x90a49228, 0x8f208f20, 0x8d9c8f20, 0x8c188c18, 0x8a948c18, 0x89108910
.long 0x93a88910, 0x92249224, 0x90a09224, 0x8f1c8f1c, 0x8d988f1c, 0x8c148c14, 0x8a908c14, 0x890c890c
.long 0x93a4890c, 0x92209220, 0x909c9220, 0x8f188f18, 0x8d948f18, 0x8c108c10, 0x8a8c8c10, 0x89088908
.long 0x93a08908, 0x921c921c, 0x9098921c, 0x8f148f14, 0x8d908f14, 0x8c0c8c0c, 0x8a888c0c, 0x89048904
.long 0x939c8904, 0x92189218, 0x90949218, 0x8f108f10, 0x8d8c8f10, 0x8c088c08, 0x8a848c08, 0x89008900
.long 0x92149398, 0x8f0c9090, 0x8c048d88, 0x88fc8a80, 0x92109394, 0x8f08908c, 0x8c008d84, 0x88f88a7c
.long 0x920c9390, 0x8f049088, 0x8bfc8d80, 0x88f48a78, 0x9208938c, 0x8f009084, 0x8bf88d7c, 0x88f08a74
.long 0x92049388, 0x8efc9080, 0x8bf48d78, 0x88ec8a70, 0x92009384, 0x8ef8907c, 0x8bf08d74, 0x88e88a6c
.long 0x91fc9380, 0x8ef49078, 0x8bec8d70, 0x88e48a68, 0x91f8937c, 0x8ef09074, 0x8be88d6c, 0x88e08a64
.long 0x91f49378, 0x8eec9070, 0x8be48d68, 0x88dc8a60, 0x91f09374, 0x8ee8906c, 0x8be08d64, 0x88d88a5c
.long 0x91ec9370, 0x8ee49068, 0x8bdc8d60, 0x88d48a58, 0x91e8936c, 0x8ee09064, 0x8bd88d5c, 0x88d08a54
.long 0x91e49368, 0x8edc9060, 0x8bd48d58, 0x88cc8a50, 0x91e09364, 0x8ed8905c, 0x8bd08d54, 0x88c88a4c
.long 0x91dc9360, 0x8ed49058, 0x8bcc8d50, 0x88c48a48, 0x91d8935c, 0x8ed09054, 0x8bc88d4c, 0x88c08a44
.long 0x91d49358, 0x8ecc9050, 0x8bc48d48, 0x88bc8a40, 0x91d09354, 0x8ec8904c, 0x8bc08d44, 0x88b88a3c
.long 0x91cc9350, 0x8ec49048, 0x8bbc8d40, 0x88b48a38, 0x91c8934c, 0x8ec09044, 0x8bb88d3c, 0x88b08a34
.long 0x91c49348, 0x8ebc9040, 0x8bb48d38, 0x88ac8a30, 0x91c09344, 0x8eb8903c, 0x8bb08d34, 0x88a88a2c
.long 0x91bc9340, 0x8eb49038, 0x8bac8d30, 0x88a48a28, 0x91b8933c, 0x8eb09034, 0x8ba88d2c, 0x88a08a24
.long 0x91b49338, 0x8eac9030, 0x8ba48d28, 0x889c8a20, 0x91b09334, 0x8ea8902c, 0x8ba08d24, 0x88988a1c
.long 0x91ac9330, 0x8ea49028, 0x8b9c8d20, 0x88948a18, 0x91a8932c, 0x8ea09024, 0x8b988d1c, 0x88908a14
.long 0x91a49328, 0x8e9c9020, 0x8b948d18, 0x888c8a10, 0x91a09324, 0x8e98901c, 0x8b908d14, 0x88888a0c
.long 0x919c9320, 0x8e949018, 0x8b8c8d10, 0x88848a08, 0x9198931c, 0x8e909014, 0x8b888d0c, 0x88808a04
.long 0x8a008a00, 0x8a008a00, 0x8a008a00, 0x8a008a00, 0x8a008a00, 0x8a008a00, 0x8a008a00, 0x8a008a00
.long 0x8f8c8980, 0x8f88897c, 0x8f848978, 0x8f808974, 0x8f7c8970, 0x8f78896c, 0x8f748968, 0x8f708964
.long 0x8f6c8960, 0x8f68895c, 0x8f648958, 0x8f608954, 0x8f5c8950, 0x8f58894c, 0x8f548948, 0x8f508944
.long 0x8a008a00, 0x8a008a00, 0x8a008a00, 0x8a008a00, 0x8a008a00, 0x8a008a00, 0x8a008a00, 0x8a008a00
.long 0x8b009110, 0x8afc910c, 0x8af89108, 0x8af49104, 0x8af09100, 0x8aec90fc, 0x8ae890f8, 0x8ae490f4
.long 0x8ae090f0, 0x8adc90ec, 0x8ad890e8, 0x8ad490e4, 0x8ad090e0, 0x8acc90dc, 0x8ac890d8, 0x8a0090d4
.long 0x8a008a00, 0x8a008a00, 0x8a008a00, 0x8a008a00, 0x8a008a00, 0x8a008a00, 0x8a008a00, 0x8a008a00
.long 0x8c849294, 0x8c809290, 0x8c7c928c, 0x8c789288, 0x8c749284, 0x8c709280, 0x8c6c927c, 0x8c689278
.long 0x8c649274, 0x8c609270, 0x8c5c926c, 0x8c589268, 0x8c549264, 0x8c509260, 0x8c4c925c, 0x8a009258
.long 0x8a008a00, 0x8a008a00, 0x8a008a00, 0x8a008a00, 0x8a008a00, 0x8a008a00, 0x8a008a00, 0x8a008a00
.long 0x8e089418, 0x8e049414, 0x8e009410, 0x8dfc940c, 0x8df89408, 0x8df49404, 0x8df09400, 0x8dec93fc
.long 0x8de893f8, 0x8de493f4, 0x8de093f0, 0x8ddc93ec, 0x8dd893e8, 0x8dd493e4, 0x8dd093e0, 0x8a0093dc
.long 0x8a008a00, 0x8a008a00, 0x8a008a00, 0x8a008a00, 0x8a008a00, 0x8a008a00, 0x8a008a00, 0x8a008a00
.long 0x92d489c0, 0x8cc48fcc, 0x92d089bc, 0x8cc08fc8, 0x92cc89b8, 0x8cbc8fc4, 0x92c889b4, 0x8cb88fc0
.long 0x92c489b0, 0x8cb48fbc, 0x92c089ac, 0x8cb08fb8, 0x92bc89a8, 0x8cac8fb4, 0x92b889a4, 0x8ca88fb0
.long 0x92b489a0, 0x8ca48fac, 0x92b0899c, 0x8ca08fa8, 0x92ac8998, 0x8c9c8fa4, 0x92a88994, 0x8c988fa0
.long 0x92a48990, 0x8c948f9c, 0x92a0898c, 0x8c908f98, 0x929c8988, 0x8c8c8f94, 0x92988984, 0x8c888f90
.long 0x8a008a00, 0x8a008a00, 0x8a008a00, 0x8a008a00, 0x8a008a00, 0x8a008a00, 0x8a008a00, 0x8a008a00
.long 0x91509458, 0x8b408e48, 0x914c9454, 0x8b3c8e44, 0x91489450, 0x8b388e40, 0x9144944c, 0x8b348e3c
.long 0x91409448, 0x8b308e38, 0x913c9444, 0x8b2c8e34, 0x91389440, 0x8b288e30, 0x9134943c, 0x8b248e2c
.long 0x91309438, 0x8b208e28, 0x912c9434, 0x8b1c8e24, 0x91289430, 0x8b188e20, 0x9124942c, 0x8b148e1c
.long 0x91209428, 0x8b108e18, 0x911c9424, 0x8b0c8e14, 0x91189420, 0x8b088e10, 0x9114941c, 0x8b048e0c
.long 0x8a008a00, 0x8a008a00, 0x8a008a00, 0x8a008a00, 0x8a008a00, 0x8a008a00, 0x8a008a00, 0x8a008a00
.long 0x8a008a00, 0x8a008a00, 0x8a008a00, 0x8a008a00, 0x8a008a00, 0x89808a00, 0x8a008980, 0x8a008a00
.long 0x96209620, 0x96209620, 0x96209620, 0x96209620, 0x96209620, 0x96209620, 0x96209620, 0x96209620
.long 0x96209620, 0x99ec99ec, 0x986899ec, 0x98689868, 0x98689868, 0x96e496e4, 0x956096e4, 0x95609560
.long 0x9ff89560, 0x9e749e74, 0x9cf09e74, 0x9b6c9b6c, 0x99e89b6c, 0x98649864, 0x96e09864, 0x955c955c
.long 0x9ff4955c, 0x9e709e70, 0x9cec9e70, 0x9b689b68, 0x99e49b68, 0x98609860, 0x96dc9860, 0x95589558
.long 0x9ff09558, 0x9e6c9e6c, 0x9ce89e6c, 0x9b649b64, 0x99e09b64, 0x985c985c, 0x96d8985c, 0x95549554
.long 0x9fec9554, 0x9e689e68, 0x9ce49e68, 0x9b609b60, 0x99dc9b60, 0x98589858, 0x96d49858, 0x95509550
.long 0x9fe89550, 0x9e649e64, 0x9ce09e64, 0x9b5c9b5c, 0x99d89b5c, 0x98549854, 0x96d09854, 0x954c954c
.long 0x9fe4954c, 0x9e609e60, 0x9cdc9e60, 0x9b589b58, 0x99d49b58, 0x98509850, 0x96cc9850, 0x95489548
.long 0x9fe09548, 0x9e5c9e5c, 0x9cd89e5c, 0x9b549b54, 0x99d09b54, 0x984c984c, 0x96c8984c, 0x95449544
.long 0x9fdc9544, 0x9e589e58, 0x9cd49e58, 0x9b509b50, 0x99cc9b50, 0x98489848, 0x96c49848, 0x95409540
.long 0x9fd89540, 0x9e549e54, 0x9cd09e54, 0x9b4c9b4c, 0x99c89b4c, 0x98449844, 0x96c09844, 0x953c953c
.long 0x9fd4953c, 0x9e509e50, 0x9ccc9e50, 0x9b489b48, 0x99c49b48, 0x98409840, 0x96bc9840, 0x95389538
.long 0x9fd09538, 0x9e4c9e4c, 0x9cc89e4c, 0x9b449b44, 0x99c09b44, 0x983c983c, 0x96b8983c, 0x95349534
.long 0x9fcc9534, 0x9e489e48, 0x9cc49e48, 0x9b409b40, 0x99bc9b40, 0x98389838, 0x96b49838, 0x95309530
.long 0x9fc89530, 0x9e449e44, 0x9cc09e44, 0x9b3c9b3c, 0x99b89b3c, 0x98349834, 0x96b09834, 0x952c952c
.long 0x9fc4952c, 0x9e409e40, 0x9cbc9e40, 0x9b389b38, 0x99b49b38, 0x98309830, 0x96ac9830, 0x95289528
.long 0x9fc09528, 0x9e3c9e3c, 0x9cb89e3c, 0x9b349b34, 0x99b09b34, 0x982c982c, 0x96a8982c, 0x95249524
.long 0x9fbc9524, 0x9e389e38, 0x9cb49e38, 0x9b309b30, 0x99ac9b30, 0x98289828, 0x96a49828, 0x95209520
.long 0x9e349fb8, 0x9b2c9cb0, 0x982499a8, 0x951c96a0, 0x9e309fb4, 0x9b289cac, 0x982099a4, 0x9518969c
.long 0x9e2c9fb0, 0x9b249ca8, 0x981c99a0, 0x95149698, 0x9e289fac, 0x9b209ca4, 0x9818999c, 0x95109694
.long 0x9e249fa8, 0x9b1c9ca0, 0x98149998, 0x950c9690, 0x9e209fa4, 0x9b189c9c, 0x98109994, 0x9508968c
.long 0x9e1c9fa0, 0x9b149c98, 0x980c9990, 0x95049688, 0x9e189f9c, 0x9b109c94, 0x9808998c, 0x95009684
.long 0x9e149f98, 0x9b0c9c90, 0x98049988, 0x94fc9680, 0x9e109f94, 0x9b089c8c, 0x98009984, 0x94f8967c
.long 0x9e0c9f90, 0x9b049c88, 0x97fc9980, 0x94f49678, 0x9e089f8c, 0x9b009c84, 0x97f8997c, 0x94f09674
.long 0x9e049f88, 0x9afc9c80, 0x97f49978, 0x94ec9670, 0x9e009f84, 0x9af89c7c, 0x97f09974, 0x94e8966c
.long 0x9dfc9f80, 0x9af49c78, 0x97ec9970, 0x94e49668, 0x9df89f7c, 0x9af09c74, 0x97e8996c, 0x94e09664
.long 0x9df49f78, 0x9aec9c70, 0x97e49968, 0x94dc9660, 0x9df09f74, 0x9ae89c6c, 0x97e09964, 0x94d8965c
.long 0x9dec9f70, 0x9ae49c68, 0x97dc9960, 0x94d49658, 0x9de89f6c, 0x9ae09c64, 0x97d8995c, 0x94d09654
.long 0x9de49f68, 0x9adc9c60, 0x97d49958, 0x94cc9650, 0x9de09f64, 0x9ad89c5c, 0x97d09954, 0x94c8964c
.long 0x9ddc9f60, 0x9ad49c58, 0x97cc9950, 0x94c49648, 0x9dd89f5c, 0x9ad09c54, 0x97c8994c, 0x94c09644
.long 0x9dd49f58, 0x9acc9c50, 0x97c49948, 0x94bc9640, 0x9dd09f54, 0x9ac89c4c, 0x97c09944, 0x94b8963c
.long 0x9dcc9f50, 0x9ac49c48, 0x97bc9940, 0x94b49638, 0x9dc89f4c, 0x9ac09c44, 0x97b8993c, 0x94b09634
.long 0x9dc49f48, 0x9abc9c40, 0x97b49938, 0x94ac9630, 0x9dc09f44, 0x9ab89c3c, 0x97b09934, 0x94a8962c
.long 0x9dbc9f40, 0x9ab49c38, 0x97ac9930, 0x94a49628, 0x9db89f3c, 0x9ab09c34, 0x97a8992c, 0x94a09624
.long 0x96209620, 0x96209620, 0x96209620, 0x96209620, 0x96209620, 0x96209620, 0x96209620, 0x96209620
.long 0x9bac95a0, 0x9ba8959c, 0x9ba49598, 0x9ba09594, 0x9b9c9590, 0x9b98958c, 0x9b949588, 0x9b909584
.long 0x9b8c9580, 0x9b88957c, 0x9b849578, 0x9b809574, 0x9b7c9570, 0x9b78956c, 0x9b749568, 0x9b709564
.long 0x96209620, 0x96209620, 0x96209620, 0x96209620, 0x96209620, 0x96209620, 0x96209620, 0x96209620
.long 0x97209d30, 0x971c9d2c, 0x97189d28, 0x97149d24, 0x97109d20, 0x970c9d1c, 0x97089d18, 0x97049d14
.long 0x97009d10, 0x96fc9d0c, 0x96f89d08, 0x96f49d04, 0x96f09d00, 0x96ec9cfc, 0x96e89cf8, 0x96209cf4
.long 0x96209620, 0x96209620, 0x96209620, 0x96209620, 0x96209620, 0x96209620, 0x96209620, 0x96209620
.long 0x98a49eb4, 0x98a09eb0, 0x989c9eac, 0x98989ea8, 0x98949ea4, 0x98909ea0, 0x988c9e9c, 0x98889e98
.long 0x98849e94, 0x98809e90, 0x987c9e8c, 0x98789e88, 0x98749e84, 0x98709e80, 0x986c9e7c, 0x96209e78
.long 0x96209620, 0x96209620, 0x96209620, 0x96209620, 0x96209620, 0x96209620, 0x96209620, 0x96209620
.long 0x9a28a038, 0x9a24a034, 0x9a20a030, 0x9a1ca02c, 0x9a18a028, 0x9a14a024, 0x9a10a020, 0x9a0ca01c
.long 0x9a08a018, 0x9a04a014, 0x9a00a010, 0x99fca00c, 0x99f8a008, 0x99f4a004, 0x99f0a000, 0x96209ffc
.long 0x96209620, 0x96209620, 0x96209620, 0x96209620, 0x96209620, 0x96209620, 0x96209620, 0x96209620
.long 0x9ef495e0, 0x98e49bec, 0x9ef095dc, 0x98e09be8, 0x9eec95d8, 0x98dc9be4, 0x9ee895d4, 0x98d89be0
.long 0x9ee495d0, 0x98d49bdc, 0x9ee095cc, 0x98d09bd8, 0x9edc95c8, 0x98cc9bd4, 0x9ed895c4, 0x98c89bd0
.long 0x9ed495c0, 0x98c49bcc, 0x9ed095bc, 0x98c09bc8, 0x9ecc95b8, 0x98bc9bc4, 0x9ec895b4, 0x98b89bc0
.long 0x9ec495b0, 0x98b49bbc, 0x9ec095ac, 0x98b09bb8, 0x9ebc95a8, 0x98ac9bb4, 0x9eb895a4, 0x98a89bb0
.long 0x96209620, 0x96209620, 0x96209620, 0x96209620, 0x96209620, 0x96209620, 0x96209620, 0x96209620
.long 0x9d70a078, 0x97609a68, 0x9d6ca074, 0x975c9a64, 0x9d68a070, 0x97589a60, 0x9d64a06c, 0x97549a5c
.long 0x9d60a068, 0x97509a58, 0x9d5ca064, 0x974c9a54, 0x9d58a060, 0x97489a50, 0x9d54a05c, 0x97449a4c
.long 0x9d50a058, 0x97409a48, 0x9d4ca054, 0x973c9a44, 0x9d48a050, 0x97389a40, 0x9d44a04c, 0x97349a3c
.long 0x9d40a048, 0x97309a38, 0x9d3ca044, 0x972c9a34, 0x9d38a040, 0x97289a30, 0x9d34a03c, 0x97249a2c
.long 0x96209620, 0x96209620, 0x96209620, 0x96209620, 0x96209620, 0x96209620, 0x96209620, 0x96209620
.long 0x96209620, 0x96209620, 0x96209620, 0x96209620, 0x96209620, 0x95a09620, 0x962095a0, 0x96209620
.long 0xa240a240, 0xa240a240, 0xa240a240, 0xa240a240, 0xa240a240, 0xa240a240, 0xa240a240, 0xa240a240
.long 0xa240a240, 0xa60ca60c, 0xa488a60c, 0xa488a488, 0xa488a488, 0xa304a304, 0xa180a304, 0xa180a180
.long 0xac18a180, 0xaa94aa94, 0xa910aa94, 0xa78ca78c, 0xa608a78c, 0xa484a484, 0xa300a484, 0xa17ca17c
.long 0xac14a17c, 0xaa90aa90, 0xa90caa90, 0xa788a788, 0xa604a788, 0xa480a480, 0xa2fca480, 0xa178a178
.long 0xac10a178, 0xaa8caa8c, 0xa908aa8c, 0xa784a784, 0xa600a784, 0xa47ca47c, 0xa2f8a47c, 0xa174a174
.long 0xac0ca174, 0xaa88aa88, 0xa904aa88, 0xa780a780, 0xa5fca780, 0xa478a478, 0xa2f4a478, 0xa170a170
.long 0xac08a170, 0xaa84aa84, 0xa900aa84, 0xa77ca77c, 0xa5f8a77c, 0xa474a474, 0xa2f0a474, 0xa16ca16c
.long 0xac04a16c, 0xaa80aa80, 0xa8fcaa80, 0xa778a778, 0xa5f4a778, 0xa470a470, 0xa2eca470, 0xa168a168
.long 0xac00a168, 0xaa7caa7c, 0xa8f8aa7c, 0xa774a774, 0xa5f0a774, 0xa46ca46c, 0xa2e8a46c, 0xa164a164
.long 0xabfca164, 0xaa78aa78, 0xa8f4aa78, 0xa770a770, 0xa5eca770, 0xa468a468, 0xa2e4a468, 0xa160a160
.long 0xabf8a160, 0xaa74aa74, 0xa8f0aa74, 0xa76ca76c, 0xa5e8a76c, 0xa464a464, 0xa2e0a464, 0xa15ca15c
.long 0xabf4a15c, 0xaa70aa70, 0xa8ecaa70, 0xa768a768, 0xa5e4a768, 0xa460a460, 0xa2dca460, 0xa158a158
.long 0xabf0a158, 0xaa6caa6c, 0xa8e8aa6c, 0xa764a764, 0xa5e0a764, 0xa45ca45c, 0xa2d8a45c, 0xa154a154
.long 0xabeca154, 0xaa68aa68, 0xa8e4aa68, 0xa760a760, 0xa5dca760, 0xa458a458, 0xa2d4a458, 0xa150a150
.long 0xabe8a150, 0xaa64aa64, 0xa8e0aa64, 0xa75ca75c, 0xa5d8a75c, 0xa454a454, 0xa2d0a454, 0xa14ca14c
.long 0xabe4a14c, 0xaa60aa60, 0xa8dcaa60, 0xa758a758, 0xa5d4a758, 0xa450a450, 0xa2cca450, 0xa148a148
.long 0xabe0a148, 0xaa5caa5c, 0xa8d8aa5c, 0xa754a754, 0xa5d0a754, 0xa44ca44c, 0xa2c8a44c, 0xa144a144
.long 0xabdca144, 0xaa58aa58, 0xa8d4aa58, 0xa750a750, 0xa5cca750, 0xa448a448, 0xa2c4a448, 0xa140a140
.long 0xaa54abd8, 0xa74ca8d0, 0xa444a5c8, 0xa13ca2c0, 0xaa50abd4, 0xa748a8cc, 0xa440a5c4, 0xa138a2bc
.long 0xaa4cabd0, 0xa744a8c8, 0xa43ca5c0, 0xa134a2b8, 0xaa48abcc, 0xa740a8c4, 0xa438a5bc, 0xa130a2b4
.long 0xaa44abc8, 0xa73ca8c0, 0xa434a5b8, 0xa12ca2b0, 0xaa40abc4, 0xa738a8bc, 0xa430a5b4, 0xa128a2ac
.long 0xaa3cabc0, 0xa734a8b8, 0xa42ca5b0, 0xa124a2a8, 0xaa38abbc, 0xa730a8b4, 0xa428a5ac, 0xa120a2a4
.long 0xaa34abb8, 0xa72ca8b0, 0xa424a5a8, 0xa11ca2a0, 0xaa30abb4, 0xa728a8ac, 0xa420a5a4, 0xa118a29c
.long 0xaa2cabb0, 0xa724a8a8, 0xa41ca5a0, 0xa114a298, 0xaa28abac, 0xa720a8a4, 0xa418a59c, 0xa110a294
.long 0xaa24aba8, 0xa71ca8a0, 0xa414a598, 0xa10ca290, 0xaa20aba4, 0xa718a89c, 0xa410a594, 0xa108a28c
.long 0xaa1caba0, 0xa714a898, 0xa40ca590, 0xa104a288, 0xaa18ab9c, 0xa710a894, 0xa408a58c, 0xa100a284
.long 0xaa14ab98, 0xa70ca890, 0xa404a588, 0xa0fca280, 0xaa10ab94, 0xa708a88c, 0xa400a584, 0xa0f8a27c
.long 0xaa0cab90, 0xa704a888, 0xa3fca580, 0xa0f4a278, 0xaa08ab8c, 0xa700a884, 0xa3f8a57c, 0xa0f0a274
.long 0xaa04ab88, 0xa6fca880, 0xa3f4a578, 0xa0eca270, 0xaa00ab84, 0xa6f8a87c, 0xa3f0a574, 0xa0e8a26c
.long 0xa9fcab80, 0xa6f4a878, 0xa3eca570, 0xa0e4a268, 0xa9f8ab7c, 0xa6f0a874, 0xa3e8a56c, 0xa0e0a264
.long 0xa9f4ab78, 0xa6eca870, 0xa3e4a568, 0xa0dca260, 0xa9f0ab74, 0xa6e8a86c, 0xa3e0a564, 0xa0d8a25c
.long 0xa9ecab70, 0xa6e4a868, 0xa3dca560, 0xa0d4a258, 0xa9e8ab6c, 0xa6e0a864, 0xa3d8a55c, 0xa0d0a254
.long 0xa9e4ab68, 0xa6dca860, 0xa3d4a558, 0xa0cca250, 0xa9e0ab64, 0xa6d8a85c, 0xa3d0a554, 0xa0c8a24c
.long 0xa9dcab60, 0xa6d4a858, 0xa3cca550, 0xa0c4a248, 0xa9d8ab5c, 0xa6d0a854, 0xa3c8a54c, 0xa0c0a244
.long 0xa240a240, 0xa240a240, 0xa240a240, 0xa240a240, 0xa240a240, 0xa240a240, 0xa240a240, 0xa240a240
.long 0xa7cca1c0, 0xa7c8a1bc, 0xa7c4a1b8, 0xa7c0a1b4, 0xa7bca1b0, 0xa7b8a1ac, 0xa7b4a1a8, 0xa7b0a1a4
.long 0xa7aca1a0, 0xa7a8a19c, 0xa7a4a198, 0xa7a0a194, 0xa79ca190, 0xa798a18c, 0xa794a188, 0xa790a184
.long 0xa240a240, 0xa240a240, 0xa240a240, 0xa240a240, 0xa240a240, 0xa240a240, 0xa240a240, 0xa240a240
.long 0xa340a950, 0xa33ca94c, 0xa338a948, 0xa334a944, 0xa330a940, 0xa32ca93c, 0xa328a938, 0xa324a934
.long 0xa320a930, 0xa31ca92c, 0xa318a928, 0xa314a924, 0xa310a920, 0xa30ca91c, 0xa308a918, 0xa240a914
.long 0xa240a240, 0xa240a240, 0xa240a240, 0xa240a240, 0xa240a240, 0xa240a240, 0xa240a240, 0xa240a240
.long 0xa4c4aad4, 0xa4c0aad0, 0xa4bcaacc, 0xa4b8aac8, 0xa4b4aac4, 0xa4b0aac0, 0xa4acaabc, 0xa4a8aab8
.long 0xa4a4aab4, 0xa4a0aab0, 0xa49caaac, 0xa498aaa8, 0xa494aaa4, 0xa490aaa0, 0xa48caa9c, 0xa240aa98
.long 0xa240a240, 0xa240a240, 0xa240a240, 0xa240a240, 0xa240a240, 0xa240a240, 0xa240a240, 0xa240a240
.long 0xa648ac58, 0xa644ac54, 0xa640ac50, 0xa63cac4c, 0xa638ac48, 0xa634ac44, 0xa630ac40, 0xa62cac3c
.long 0xa628ac38, 0xa624ac34, 0xa620ac30, 0xa61cac2c, 0xa618ac28, 0xa614ac24, 0xa610ac20, 0xa240ac1c
.long 0xa240a240, 0xa240a240, 0xa240a240, 0xa240a240, 0xa240a240, 0xa240a240, 0xa240a240, 0xa240a240
.long 0xab14a200, 0xa504a80c, 0xab10a1fc, 0xa500a808, 0xab0ca1f8, 0xa4fca804, 0xab08a1f4, 0xa4f8a800
.long 0xab04a1f0, 0xa4f4a7fc, 0xab00a1ec, 0xa4f0a7f8, 0xaafca1e8, 0xa4eca7f4, 0xaaf8a1e4, 0xa4e8a7f0
.long 0xaaf4a1e0, 0xa4e4a7ec, 0xaaf0a1dc, 0xa4e0a7e8, 0xaaeca1d8, 0xa4dca7e4, 0xaae8a1d4, 0xa4d8a7e0
.long 0xaae4a1d0, 0xa4d4a7dc, 0xaae0a1cc, 0xa4d0a7d8, 0xaadca1c8, 0xa4cca7d4, 0xaad8a1c4, 0xa4c8a7d0
.long 0xa240a240, 0xa240a240, 0xa240a240, 0xa240a240, 0xa240a240, 0xa240a240, 0xa240a240, 0xa240a240
.long 0xa990ac98, 0xa380a688, 0xa98cac94, 0xa37ca684, 0xa988ac90, 0xa378a680, 0xa984ac8c, 0xa374a67c
.long 0xa980ac88, 0xa370a678, 0xa97cac84, 0xa36ca674, 0xa978ac80, 0xa368a670, 0xa974ac7c, 0xa364a66c
.long 0xa970ac78, 0xa360a668, 0xa96cac74, 0xa35ca664, 0xa968ac70, 0xa358a660, 0xa964ac6c, 0xa354a65c
.long 0xa960ac68, 0xa350a658, 0xa95cac64, 0xa34ca654, 0xa958ac60, 0xa348a650, 0xa954ac5c, 0xa344a64c
.long 0xa240a240, 0xa240a240, 0xa240a240, 0xa240a240, 0xa240a240, 0xa240a240, 0xa240a240, 0xa240a240
.long 0xa240a240, 0xa240a240, 0xa240a240, 0xa240a240, 0xa240a240, 0xa1c0a240, 0xa240a1c0, 0xa240a240
.long 0xae60ae60, 0xae60ae60, 0xae60ae60, 0xae60ae60, 0xae60ae60, 0xae60ae60, 0xae60ae60, 0xae60ae60
.long 0xae60ae60, 0xb22cb22c, 0xb0a8b22c, 0xb0a8b0a8, 0xb0a8b0a8, 0xaf24af24, 0xada0af24, 0xada0ada0
.long 0xb838ada0, 0xb6b4b6b4, 0xb530b6b4, 0xb3acb3ac, 0xb228b3ac, 0xb0a4b0a4, 0xaf20b0a4, 0xad9cad9c
.long 0xb834ad9c, 0xb6b0b6b0, 0xb52cb6b0, 0xb3a8b3a8, 0xb224b3a8, 0xb0a0b0a0, 0xaf1cb0a0, 0xad98ad98
.long 0xb830ad98, 0xb6acb6ac, 0xb528b6ac, 0xb3a4b3a4, 0xb220b3a4, 0xb09cb09c, 0xaf18b09c, 0xad94ad94
.long 0xb82cad94, 0xb6a8b6a8, 0xb524b6a8, 0xb3a0b3a0, 0xb21cb3a0, 0xb098b098, 0xaf14b098, 0xad90ad90
.long 0xb828ad90, 0xb6a4b6a4, 0xb520b6a4, 0xb39cb39c, 0xb218b39c, 0xb094b094, 0xaf10b094, 0xad8cad8c
.long 0xb824ad8c, 0xb6a0b6a0, 0xb51cb6a0, 0xb398b398, 0xb214b398, 0xb090b090, 0xaf0cb090, 0xad88ad88
.long 0xb820ad88, 0xb69cb69c, 0xb518b69c, 0xb394b394, 0xb210b394, 0xb08cb08c, 0xaf08b08c, 0xad84ad84
.long 0xb81cad84, 0xb698b698, 0xb514b698, 0xb390b390, 0xb20cb390, 0xb088b088, 0xaf04b088, 0xad80ad80
.long 0xb818ad80, 0xb694b694, 0xb510b694, 0xb38cb38c, 0xb208b38c, 0xb084b084, 0xaf00b084, 0xad7cad7c
.long 0xb814ad7c, 0xb690b690, 0xb50cb690, 0xb388b388, 0xb204b388, 0xb080b080, 0xaefcb080, 0xad78ad78
.long 0xb810ad78, 0xb68cb68c, 0xb508b68c, 0xb384b384, 0xb200b384, 0xb07cb07c, 0xaef8b07c, 0xad74ad74
.long 0xb80cad74, 0xb688b688, 0xb504b688, 0xb380b380, 0xb1fcb380, 0xb078b078, 0xaef4b078, 0xad70ad70
.long 0xb808ad70, 0xb684b684, 0xb500b684, 0xb37cb37c, 0xb1f8b37c, 0xb074b074, 0xaef0b074, 0xad6cad6c
.long 0xb804ad6c, 0xb680b680, 0xb4fcb680, 0xb378b378, 0xb1f4b378, 0xb070b070, 0xaeecb070, 0xad68ad68
.long 0xb800ad68, 0xb67cb67c, 0xb4f8b67c, 0xb374b374, 0xb1f0b374, 0xb06cb06c, 0xaee8b06c, 0xad64ad64
.long 0xb7fcad64, 0xb678b678, 0xb4f4b678, 0xb370b370, 0xb1ecb370, 0xb068b068, 0xaee4b068, 0xad60ad60
.long 0xb674b7f8, 0xb36cb4f0, 0xb064b1e8, 0xad5caee0, 0xb670b7f4, 0xb368b4ec, 0xb060b1e4, 0xad58aedc
.long 0xb66cb7f0, 0xb364b4e8, 0xb05cb1e0, 0xad54aed8, 0xb668b7ec, 0xb360b4e4, 0xb058b1dc, 0xad50aed4
.long 0xb664b7e8, 0xb35cb4e0, 0xb054b1d8, 0xad4caed0, 0xb660b7e4, 0xb358b4dc, 0xb050b1d4, 0xad48aecc
.long 0xb65cb7e0, 0xb354b4d8, 0xb04cb1d0, 0xad44aec8, 0xb658b7dc, 0xb350b4d4, 0xb048b1cc, 0xad40aec4
.long 0xb654b7d8, 0xb34cb4d0, 0xb044b1c8, 0xad3caec0, 0xb650b7d4, 0xb348b4cc, 0xb040b1c4, 0xad38aebc
.long 0xb64cb7d0, 0xb344b4c8, 0xb03cb1c0, 0xad34aeb8, 0xb648b7cc, 0xb340b4c4, 0xb038b1bc, 0xad30aeb4
.long 0xb644b7c8, 0xb33cb4c0, 0xb034b1b8, 0xad2caeb0, 0xb640b7c4, 0xb338b4bc, 0xb030b1b4, 0xad28aeac
.long 0xb63cb7c0, 0xb334b4b8, 0xb02cb1b0, 0xad24aea8, 0xb638b7bc, 0xb330b4b4, 0xb028b1ac, 0xad20aea4
.long 0xb634b7b8, 0xb32cb4b0, 0xb024b1a8, 0xad1caea0, 0xb630b7b4, 0xb328b4ac, 0xb020b1a4, 0xad18ae9c
.long 0xb62cb7b0, 0xb324b4a8, 0xb01cb1a0, 0xad14ae98, 0xb628b7ac, 0xb320b4a4, 0xb018b19c, 0xad10ae94
.long 0xb624b7a8, 0xb31cb4a0, 0xb014b198, 0xad0cae90, 0xb620b7a4, 0xb318b49c, 0xb010b194, 0xad08ae8c
.long 0xb61cb7a0, 0xb314b498, 0xb00cb190, 0xad04ae88, 0xb618b79c, 0xb310b494, 0xb008b18c, 0xad00ae84
.long 0xb614b798, 0xb30cb490, 0xb004b188, 0xacfcae80, 0xb610b794, 0xb308b48c, 0xb000b184, 0xacf8ae7c
.long 0xb60cb790, 0xb304b488, 0xaffcb180, 0xacf4ae78, 0xb608b78c, 0xb300b484, 0xaff8b17c, 0xacf0ae74
.long 0xb604b788, 0xb2fcb480, 0xaff4b178, 0xacecae70, 0xb600b784, 0xb2f8b47c, 0xaff0b174, 0xace8ae6c
.long 0xb5fcb780, 0xb2f4b478, 0xafecb170, 0xace4ae68, 0xb5f8b77c, 0xb2f0b474, 0xafe8b16c, 0xace0ae64
.long 0xae60ae60, 0xae60ae60, 0xae60ae60, 0xae60ae60, 0xae60ae60, 0xae60ae60, 0xae60ae60, 0xae60ae60
.long 0xb3ecade0, 0xb3e8addc, 0xb3e4add8, 0xb3e0add4, 0xb3dcadd0, 0xb3d8adcc, 0xb3d4adc8, 0xb3d0adc4
.long 0xb3ccadc0, 0xb3c8adbc, 0xb3c4adb8, 0xb3c0adb4, 0xb3bcadb0, 0xb3b8adac, 0xb3b4ada8, 0xb3b0ada4
.long 0xae60ae60, 0xae60ae60, 0xae60ae60, 0xae60ae60, 0xae60ae60, 0xae60ae60, 0xae60ae60, 0xae60ae60
.long 0xaf60b570, 0xaf5cb56c, 0xaf58b568, 0xaf54b564, 0xaf50b560, 0xaf4cb55c, 0xaf48b558, 0xaf44b554
.long 0xaf40b550, 0xaf3cb54c, 0xaf38b548, 0xaf34b544, 0xaf30b540, 0xaf2cb53c, 0xaf28b538, 0xae60b534
.long 0xae60ae60, 0xae60ae60, 0xae60ae60, 0xae60ae60, 0xae60ae60, 0xae60ae60, 0xae60ae60, 0xae60ae60
.long 0xb0e4b6f4, 0xb0e0b6f0, 0xb0dcb6ec, 0xb0d8b6e8, 0xb0d4b6e4, 0xb0d0b6e0, 0xb0ccb6dc, 0xb0c8b6d8
.long 0xb0c4b6d4, 0xb0c0b6d0, 0xb0bcb6cc, 0xb0b8b6c8, 0xb0b4b6c4, 0xb0b0b6c0, 0xb0acb6bc, 0xae60b6b8
.long 0xae60ae60, 0xae60ae60, 0xae60ae60, 0xae60ae60, 0xae60ae60, 0xae60ae60, 0xae60ae60, 0xae60ae60
.long 0xb268b878, 0xb264b874, 0xb260b870, 0xb25cb86c, 0xb258b868, 0xb254b864, 0xb250b860, 0xb24cb85c
.long 0xb248b858, 0xb244b854, 0xb240b850, 0xb23cb84c, 0xb238b848, 0xb234b844, 0xb230b840, 0xae60b83c
.long 0xae60ae60, 0xae60ae60, 0xae60ae60, 0xae60ae60, 0xae60ae60, 0xae60ae60, 0xae60ae60, 0xae60ae60
.long 0xb734ae20, 0xb124b42c, 0xb730ae1c, 0xb120b428, 0xb72cae18, 0xb11cb424, 0xb728ae14, 0xb118b420
.long 0xb724ae10, 0xb114b41c, 0xb720ae0c, 0xb110b418, 0xb71cae08, 0xb10cb414, 0xb718ae04, 0xb108b410
.long 0xb714ae00, 0xb104b40c, 0xb710adfc, 0xb100b408, 0xb70cadf8, 0xb0fcb404, 0xb708adf4, 0xb0f8b400
.long 0xb704adf0, 0xb0f4b3fc, 0xb700adec, 0xb0f0b3f8, 0xb6fcade8, 0xb0ecb3f4, 0xb6f8ade4, 0xb0e8b3f0
.long 0xae60ae60, 0xae60ae60, 0xae60ae60, 0xae60ae60, 0xae60ae60, 0xae60ae60, 0xae60ae60, 0xae60ae60
.long 0xb5b0b8b8, 0xafa0b2a8, 0xb5acb8b4, 0xaf9cb2a4, 0xb5a8b8b0, 0xaf98b2a0, 0xb5a4b8ac, 0xaf94b29c
.long 0xb5a0b8a8, 0xaf90b298, 0xb59cb8a4, 0xaf8cb294, 0xb598b8a0, 0xaf88b290, 0xb594b89c, 0xaf84b28c
.long 0xb590b898, 0xaf80b288, 0xb58cb894, 0xaf7cb284, 0xb588b890, 0xaf78b280, 0xb584b88c, 0xaf74b27c
.long 0xb580b888, 0xaf70b278, 0xb57cb884, 0xaf6cb274, 0xb578b880, 0xaf68b270, 0xb574b87c, 0xaf64b26c
.long 0xae60ae60, 0xae60ae60, 0xae60ae60, 0xae60ae60, 0xae60ae60, 0xae60ae60, 0xae60ae60, 0xae60ae60
.long 0xae60ae60, 0xae60ae60, 0xae60ae60, 0xae60ae60, 0xae60ae60, 0xade0ae60, 0xae60ade0, 0xae60ae60
.long 0x8a008a00, 0x8a008a00, 0x8a008a00, 0x8a008a00, 0x8a008a00, 0x8a008a00, 0x8a008a00, 0x8a008a00
.long 0x8a008a00, 0x8a008a00, 0x8a008a00, 0x8a008a00, 0x8a008a00, 0x8b848b84, 0x8a008b84, 0x8a008a00
.long 0x8a008a00, 0x8a008a00, 0x8a008a00, 0x8a008a00, 0x8a008a00, 0x8a008a00, 0x8a008a00, 0x8a008a00
.long 0x8a008a00, 0x8a008a00, 0x8a008a00, 0x8a008a00, 0x8a008a00, 0x8a008a00, 0x8a008a00, 0x8a008a00
.long 0x8a008a00, 0x8a008a00, 0x8a008a00, 0x8a008a00, 0x8a008a00, 0x8a008a00, 0x8b848a00, 0x8b848b84
.long 0x8b848b84, 0x8a008a00, 0x8a008a00, 0x8a008a00, 0x8a008a00, 0x8a008a00, 0x8a008a00, 0x8a008a00
.long 0x8a008a00, 0x8a008a00, 0x8a008a00, 0x8a008a00, 0x8a008a00, 0x8a008a00, 0x8a008a00, 0x8a008a00
.long 0x8a008a00, 0x8a008a00, 0x8a008a00, 0x8a008a00, 0x8a008a00, 0x8b848a00, 0x8b848b84, 0x8b848b84
.long 0x8b848b84, 0x8b848b84, 0x8a008a00, 0x8a008a00, 0x8a008a00, 0x8a008a00, 0x8a008a00, 0x8a008a00
.long 0x8a008a00, 0x8a008a00, 0x8a008a00, 0x8a008a00, 0x8a008a00, 0x8a008a00, 0x8a008a00, 0x8a008a00
.long 0x8a008a00, 0x8a008a00, 0x8a008a00, 0x8a008a00, 0x8a008a00, 0x8a008a00, 0x8b848b84, 0x8b848b84
.long 0x8b848b84, 0x8a008b84, 0x8a008a00, 0x8a008a00, 0x8a008a00, 0x8a008a00, 0x8a008a00, 0x8a008a00
.long 0x8a008a00, 0x8a008a00, 0x8a008a00, 0x8a008a00, 0x8a008a00, 0x8a008a00, 0x8a008a00, 0x8a008a00
.long 0x8a008a00, 0x8a008a00, 0x8a008a00, 0x8a008a00, 0x8a008a00, 0x8a008a00, 0x8a008a00, 0x8a008a00
.long 0x8a008a00, 0x8a008a00, 0x8a008a00, 0x8a008a00, 0x8a008a00, 0x8a008a00, 0x8a008a00, 0x8a008a00
.long 0x8a008a00, 0x8a008a00, 0x8a008a00, 0x8a008a00, 0x8a008a00, 0x8a008a00, 0x8a008a00, 0x8a008a00
.long 0x8a008a00, 0x8a008a00, 0x8a008a00, 0x8a008a00, 0x8a008a00, 0x8a008a00, 0x8a008a00, 0x8a008a00
.long 0x8a008a00, 0x8a008a00, 0x8a008a00, 0x8a008a00, 0x8a008a00, 0x8a008a00, 0x8a008a00, 0x8a008a00
.long 0x8a008a00, 0x8a008a00, 0x8a008a00, 0x8a008a00, 0x8a008a00, 0x8a008a00, 0x8a008a00, 0x8a008a00
.long 0x8a008a00, 0x8a008a00, 0x8a008a00, 0x8a008a00, 0x8a008a00, 0x8a008a00, 0x8a008a00, 0x8a008a00
.long 0x8a008a00, 0x8a008a00, 0x8a008a00, 0x8a008a00, 0x8a008a00, 0x8a008a00, 0x8a008a00, 0x8a008a00
.long 0x8a008a00, 0x8a008a00, 0x8a008a00, 0x8a008a00, 0x8a008a00, 0x8a008a00, 0x8a008a00, 0x8a008a00
.long 0x8a008a00, 0x8a008a00, 0x8a008a00, 0x8a008a00, 0x8a008a00, 0x8a008a00, 0x8a008a00, 0x8a008a00
.long 0x8a008a00, 0x8a008a00, 0x8a008a00, 0x8a008a00, 0x8a008a00, 0x8a008a00, 0x8a008a00, 0x8a008a00
.long 0x00008a00, 0, 0, 0
L_codeend:
.section .rodata,"a"
.p2align 6
.amdhsa_kernel concat_heads__ssm_conv_s4__spectral_gfnet__prompt_kernel
  .amdhsa_next_free_vgpr 168
  .amdhsa_next_free_sgpr 102
  .amdhsa_accum_offset 168
  .amdhsa_group_segment_fixed_size 0
  .amdhsa_kernarg_size 120
  .amdhsa_user_sgpr_count 2
  .amdhsa_user_sgpr_kernarg_segment_ptr 1
  .amdhsa_system_sgpr_workgroup_id_x 1
.end_amdhsa_kernel
```
